```python
import torch

def _softmax(x, axis=-1):
    return torch.softmax(x, dim=axis)
def _gelu(x):
    return torch.nn.functional.gelu(x, approximate="tanh")
def _silu(x):
    return torch.nn.functional.silu(x)
def _sigmoid(x):
    return torch.sigmoid(x)
def _layernorm(x, axis=-1, eps=1e-5):
    m = x.mean(dim=axis, keepdim=True)
    v = x.var(dim=axis, keepdim=True, unbiased=False)
    return (x - m) / torch.sqrt(v + eps)
def _scatter_add(tgt, idx, src, axis=0):
    return tgt.clone().index_add_(axis, idx, src)
def _segment_sum(src, seg, n):
    out = torch.zeros((n,) + src.shape[1:], dtype=src.dtype)
    return out.index_add_(0, seg, src)
def _pad(x, pw):
    flat = tuple(v for pair in reversed(pw) for v in pair)
    return torch.nn.functional.pad(x, flat)

kernel_name = 'sequential_preLN__gqa_block_cached__geglu_ffn__decode'

def setup_inputs():

    _w = (lambda a: (lambda t: t.to(torch.bfloat16) if t.is_floating_point() else t)(torch.as_tensor(a)))
    def _A_setup():
        B, Sq, D = 2, 1, 448
        Hq, Hkv, Sk, Dh = 16, 8, 8192, 256
        assert Hq % Hkv == 0, (Hq, Hkv)
        return {
            "x": _w((lambda *s: torch.randn(*s, dtype=torch.bfloat16) * 0.05)(B, Sq, D)),
            "k_cache": _w((lambda *s: torch.randn(*s, dtype=torch.bfloat16) * 3.2)(B, Hkv, Sk, Dh)),
            "v_cache": _w((lambda *s: torch.randn(*s, dtype=torch.bfloat16) * 0.4)(B, Hkv, Sk, Dh)),
            "wq": _w((lambda *s: torch.randn(*s, dtype=torch.bfloat16) * 3.2)(D, Hq * Dh) * (D ** -0.5)),
            "wo": _w((lambda *s: torch.randn(*s, dtype=torch.bfloat16) * 0.4)(Hq * Dh, D) * ((Hq * Dh) ** -0.5)),
        }
    _A_in = _A_setup()

    def _B_setup():
        B, S, D, F = 2, 1, 448, 1792
        return {
            "x": _w((lambda *s: torch.randn(*s, dtype=torch.bfloat16) * 0.05)(B, S, D)),
            "w_gate": _w((lambda *s: torch.randn(*s, dtype=torch.bfloat16) * 0.05)(D, F)),
            "w_up": _w((lambda *s: torch.randn(*s, dtype=torch.bfloat16) * 0.05)(D, F)),
            "w_down": _w((lambda *s: torch.randn(*s, dtype=torch.bfloat16) * 0.05)(F, D)),
        }
    _B_in = _B_setup()

    return {
        "A_x": _A_in["x"],
        "A_k_cache": _A_in["k_cache"],
        "A_v_cache": _A_in["v_cache"],
        "A_wq": _A_in["wq"],
        "A_wo": _A_in["wo"],
        "B_x": _B_in["x"],
        "B_w_gate": _B_in["w_gate"],
        "B_w_up": _B_in["w_up"],
        "B_w_down": _B_in["w_down"],
    }

def reference(A_x, A_k_cache, A_v_cache, A_wq, A_wo, B_x, B_w_gate, B_w_up, B_w_down):
    def _A_ref(x, k_cache, v_cache, wq, wo):
        B, Sq, D = x.shape
        Hq, Dh = 16, 256
        Hkv = k_cache.shape[1]
        rep = Hq // Hkv
        q = (lambda x, *d: x.permute(*d))((x @ wq).reshape(B, Sq, Hq, Dh), 0, 2, 1, 3)
        k = (lambda x, n, axis: torch.repeat_interleave(x, n, dim=axis))(k_cache, rep, axis=1)
        v = (lambda x, n, axis: torch.repeat_interleave(x, n, dim=axis))(v_cache, rep, axis=1)
        scores = torch.einsum("bhqd,bhkd->bhqk", q, k) * (Dh ** -0.5)
        p = _softmax(scores, axis=-1)
        o = torch.einsum("bhqk,bhkd->bhqd", p, v)
        return (lambda x, *d: x.permute(*d))(o, 0, 2, 1, 3).reshape(B, Sq, Hq * Dh) @ wo

    def _B_ref(x, w_gate, w_up, w_down):
        return (_gelu(x @ w_gate) * (x @ w_up)) @ w_down

    x = A_x
    h = x + _A_ref(_layernorm(x, axis=-1), A_k_cache, A_v_cache, A_wq, A_wo)
    h2 = h + _B_ref(_layernorm(h, axis=-1), B_w_gate, B_w_up, B_w_down)
    return h2
```

```asm
; @launch grid=(256,1,1) block=(768,1,1) lds=163840
.amdgcn_target "amdgcn-amd-amdhsa--gfx950"
.text
.globl sequential_preLN__gqa_block_cached__geglu_ffn__decode_kernel
.p2align 8
.type sequential_preLN__gqa_block_cached__geglu_ffn__decode_kernel,@function
sequential_preLN__gqa_block_cached__geglu_ffn__decode_kernel:
    s_cmp_ge_u32 s2, 256
    s_cbranch_scc1 L_end
    s_load_dwordx16 s[16:31], s[0:1], 0
    s_load_dwordx8 s[32:39], s[0:1], 64
    v_lshrrev_b32 v1, 6, v0
    v_and_b32 v0, 63, v0
    v_readfirstlane_b32 s3, v1
    s_nop 0
    s_cmp_lt_u32 s3, 8
    s_cselect_b32 s4, 4, -8
    s_add_u32 s3, s3, s4
    s_and_b32 s4, s2, 7
    s_lshr_b32 s2, s2, 3
    s_cmp_eq_u32 s4, 0
    s_cbranch_scc1 L_role
    s_mul_i32 s2, s2, 7
    s_add_u32 s2, s2, s4
    s_cmp_lt_u32 s4, 0
    s_addc_u32 s2, s2, 31
    s_sub_u32 s7, s2, 32
    s_and_b32 s8, s7, 15
    s_lshr_b32 s6, s7, 4
    s_cmp_lt_u32 s3, 4
    s_cbranch_scc1 L_help
    s_sub_u32 s3, s3, 4
    v_bfe_u32 v1, v0, 2, 3
    v_lshlrev_b32 v1, 9, v1
    v_and_b32 v3, 3, v0
    v_lshl_add_u32 v1, v3, 4, v1
    v_lshrrev_b32 v3, 5, v0
    v_lshl_add_u32 v1, v3, 6, v1
    s_lshl_b32 s59, s8, 22
    s_lshl_b32 s10, s6, 6
    s_add_u32 s10, s10, s3
    s_lshl_b32 s10, s10, 12
    s_add_u32 s48, s59, s10
    s_mov_b32 s42, 0x4000000
    s_mov_b32 s43, 0x00020000
    s_waitcnt lgkmcnt(0)
    s_mov_b32 s40, s18
    s_and_b32 s41, s19, 0xffff
    buffer_load_dwordx4 v[40:43], v1, s[40:43], s48 offen offset:0 nt
    buffer_load_dwordx4 v[44:47], v1, s[40:43], s48 offen offset:128 nt
    buffer_load_dwordx4 v[48:51], v1, s[40:43], s48 offen offset:256 nt
    v_lshrrev_b32 v2, 4, v0
    v_lshlrev_b32 v2, 9, v2
    v_and_b32 v3, 15, v0
    v_lshl_add_u32 v2, v3, 4, v2
    s_add_u32 s49, s48, 32768
    s_add_u32 s50, s48, 65536
    s_add_u32 s51, s48, 98304
    s_add_u32 s52, s48, 131072
    s_add_u32 s53, s48, 163840
    s_add_u32 s54, s48, 196608
    s_add_u32 s55, s48, 229376
    s_lshl_b32 s10, s6, 3
    s_add_u32 s10, s10, s3
    s_add_u32 s10, s10, 896
    s_lshl_b32 s10, s10, 12
    s_add_u32 s56, s59, s10
    s_and_b32 s9, s6, 7
    s_cmp_eq_u32 s9, s3
    s_cselect_b32 s10, s6, 99
    s_add_u32 s9, s6, 6
    s_cmp_eq_u32 s9, s3
    s_cselect_b32 s9, 14, 0
    s_cselect_b32 s10, s6, s10
    s_add_u32 s10, s10, s9
    s_cmp_lt_u32 s10, 16
    s_cselect_b32 s11, 164, 0
    s_add_u32 s10, s10, 1008
    s_lshl_b32 s10, s10, 12
    s_add_u32 s57, s59, s10
    s_mov_b32 s44, s20
    s_and_b32 s45, s21, 0xffff
    s_mov_b32 s46, 0x4000000
    s_mov_b32 s47, 0x00020000
    v_bfe_u32 v3, v0, 2, 1
    v_lshlrev_b32 v3, 9, v3
    v_and_b32 v4, 3, v0
    v_lshl_add_u32 v3, v4, 4, v3
    v_lshrrev_b32 v4, 5, v0
    v_lshl_add_u32 v3, v4, 6, v3
    v_bfe_u32 v4, v0, 3, 1
    v_bfe_u32 v5, v0, 4, 1
    v_cmp_eq_u32 vcc, v4, v5
    v_mov_b32 v4, 1024
    s_nop 0
    v_cndmask_b32 v3, v4, v3, vcc
    v_mov_b32 v6, 0
    s_lshl_b32 s58, s3, 14
    s_add_u32 s58, s58, 24576
    v_lshlrev_b32 v5, 4, v0
    v_add_u32 v5, s58, v5
    s_mov_b32 s70, 0x22222222
    s_mov_b32 s71, 0x22222222
    s_mov_b32 s72, 0x44444444
    s_mov_b32 s73, 0x44444444
    s_mov_b32 s74, 0x88888888
    s_mov_b32 s75, 0x88888888
    s_mov_b32 s76, 0xff00ff00
    s_mov_b32 s77, 0xff00ff00
    s_mov_b32 s78, 0x3db8aa3b
    s_barrier
    s_cmp_eq_u32 s11, 164
    s_cbranch_scc1 L_body164
L_body147:
    s_waitcnt vmcnt(2)
    buffer_load_dwordx4 v[52:55], v1, s[40:43], s48 offen offset:384 nt
    s_waitcnt vmcnt(2)
    buffer_load_dwordx4 v[56:59], v1, s[40:43], s49 offen offset:0 nt
    s_waitcnt vmcnt(2)
    buffer_load_dwordx4 v[60:63], v1, s[40:43], s49 offen offset:128 nt
    s_waitcnt vmcnt(2)
    buffer_load_dwordx4 v[64:67], v1, s[40:43], s49 offen offset:256 nt
    s_waitcnt vmcnt(2)
    buffer_load_dwordx4 v[68:71], v1, s[40:43], s49 offen offset:384 nt
    s_waitcnt vmcnt(2)
    buffer_load_dwordx4 v[72:75], v1, s[40:43], s50 offen offset:0 nt
    s_waitcnt vmcnt(2)
    buffer_load_dwordx4 v[76:79], v1, s[40:43], s50 offen offset:128 nt
    s_waitcnt vmcnt(2)
    buffer_load_dwordx4 v[80:83], v1, s[40:43], s50 offen offset:256 nt
    s_waitcnt vmcnt(2)
    buffer_load_dwordx4 v[84:87], v1, s[40:43], s50 offen offset:384 nt
    s_waitcnt vmcnt(2)
    buffer_load_dwordx4 v[88:91], v1, s[40:43], s51 offen offset:0 nt
    s_waitcnt vmcnt(2)
    buffer_load_dwordx4 v[92:95], v1, s[40:43], s51 offen offset:128 nt
    s_waitcnt vmcnt(2)
    buffer_load_dwordx4 v[96:99], v1, s[40:43], s51 offen offset:256 nt
    s_waitcnt vmcnt(2)
    buffer_load_dwordx4 v[100:103], v1, s[40:43], s51 offen offset:384 nt
    s_waitcnt vmcnt(2)
    buffer_load_dwordx4 v[104:107], v1, s[40:43], s52 offen offset:0 nt
    s_waitcnt vmcnt(2)
    buffer_load_dwordx4 v[108:111], v1, s[40:43], s52 offen offset:128 nt
    s_waitcnt vmcnt(2)
    buffer_load_dwordx4 v[112:115], v1, s[40:43], s52 offen offset:256 nt
    s_waitcnt vmcnt(2)
    buffer_load_dwordx4 v[116:119], v1, s[40:43], s52 offen offset:384 nt
    s_waitcnt vmcnt(2)
    buffer_load_dwordx4 v[120:123], v1, s[40:43], s53 offen offset:0 nt
    s_waitcnt vmcnt(2)
    buffer_load_dwordx4 v[124:127], v1, s[40:43], s53 offen offset:128 nt
    s_waitcnt vmcnt(2)
    buffer_load_dwordx4 v[128:131], v1, s[40:43], s53 offen offset:256 nt
    s_waitcnt vmcnt(2)
    buffer_load_dwordx4 v[132:135], v1, s[40:43], s53 offen offset:384 nt
    s_waitcnt vmcnt(2)
    buffer_load_dwordx4 v[136:139], v1, s[40:43], s54 offen offset:0 nt
    s_waitcnt vmcnt(2)
    buffer_load_dwordx4 v[140:143], v1, s[40:43], s54 offen offset:128 nt
    s_waitcnt vmcnt(2)
    buffer_load_dwordx4 v[144:147], v1, s[40:43], s54 offen offset:256 nt
    s_waitcnt vmcnt(2)
    buffer_load_dwordx4 v[148:151], v1, s[40:43], s54 offen offset:384 nt
    s_waitcnt vmcnt(2)
    buffer_load_dwordx4 v[152:155], v1, s[40:43], s55 offen offset:0 nt
    s_waitcnt vmcnt(2)
    buffer_load_dwordx4 v[156:159], v1, s[40:43], s55 offen offset:128 nt
    s_waitcnt vmcnt(2)
    buffer_load_dwordx4 v[160:163], v1, s[40:43], s55 offen offset:256 nt
    v_mov_b32 v4, 1
    s_mov_b64 exec, 1
    ds_add_u32 v6, v4 offset:12
    s_mov_b64 exec, -1
    s_waitcnt vmcnt(2)
    buffer_load_dwordx4 v[164:167], v1, s[40:43], s55 offen offset:384 nt
    s_waitcnt vmcnt(2)
    s_add_u32 m0, s58, 0
    s_nop 0
    buffer_load_dwordx4 v1, s[40:43], s56 offen offset:0 nt lds
    s_waitcnt vmcnt(2)
    s_add_u32 m0, s58, 896
    s_nop 0
    buffer_load_dwordx4 v1, s[40:43], s56 offen offset:128 nt lds
    s_waitcnt vmcnt(2)
    s_add_u32 m0, s58, 1792
    s_nop 0
    buffer_load_dwordx4 v1, s[40:43], s56 offen offset:256 nt lds
    s_waitcnt vmcnt(2)
    s_add_u32 m0, s58, 2688
    s_nop 0
    buffer_load_dwordx4 v1, s[40:43], s56 offen offset:384 nt lds
    s_waitcnt vmcnt(2)
    s_add_u32 m0, s58, 4096
    s_nop 0
    buffer_load_dwordx4 v2, s[44:47], s48 offen offset:0 nt lds
    s_waitcnt vmcnt(2)
    s_add_u32 m0, s58, 4864
    s_nop 0
    buffer_load_dwordx4 v2, s[44:47], s48 offen offset:256 nt lds
    s_waitcnt vmcnt(2)
    s_add_u32 m0, s58, 4096
    s_nop 0
    buffer_load_dwordx4 v2, s[44:47], s48 offen offset:2048 nt lds
    s_waitcnt vmcnt(2)
    s_add_u32 m0, s58, 4864
    s_nop 0
    buffer_load_dwordx4 v2, s[44:47], s48 offen offset:2304 nt lds
    s_waitcnt vmcnt(2)
    s_mov_b32 s10, 0x30d400
L_lw_1:
    ds_read_b32 v4, v6 offset:0
    s_waitcnt lgkmcnt(0)
    v_readfirstlane_b32 s9, v4
    s_nop 0
    s_cmp_ge_u32 s9, 1
    s_cbranch_scc1 L_lwd_2
    s_sleep 2
    s_sub_u32 s10, s10, 1
    s_cbranch_scc0 L_lw_1
L_lwd_2:
    ds_read_b128 v[8:11], v3 offset:256
    ds_read_b128 v[12:15], v3 offset:384
    ds_read_b128 v[16:19], v3 offset:512
    ds_read_b128 v[20:23], v3 offset:640
    s_waitcnt lgkmcnt(0)
    v_mfma_f32_16x16x32_bf16 v[24:27], v[40:43], v[8:11], 0
    v_mfma_f32_16x16x32_bf16 v[24:27], v[44:47], v[12:15], v[24:27]
    v_mfma_f32_16x16x32_bf16 v[24:27], v[48:51], v[16:19], v[24:27]
    v_mfma_f32_16x16x32_bf16 v[24:27], v[52:55], v[20:23], v[24:27]
    buffer_load_dwordx4 v[40:43], v2, s[44:47], s49 offen offset:0 nt
    s_waitcnt vmcnt(2)
    buffer_load_dwordx4 v[44:47], v2, s[44:47], s49 offen offset:256 nt
    v_mfma_f32_16x16x32_bf16 v[28:31], v[56:59], v[8:11], 0
    v_mfma_f32_16x16x32_bf16 v[28:31], v[60:63], v[12:15], v[28:31]
    v_mfma_f32_16x16x32_bf16 v[28:31], v[64:67], v[16:19], v[28:31]
    v_mfma_f32_16x16x32_bf16 v[28:31], v[68:71], v[20:23], v[28:31]
    s_nop 0
    v_cndmask_b32 v4, v24, v25, s[70:71]
    v_cndmask_b32 v4, v4, v26, s[72:73]
    v_cndmask_b32 v4, v4, v27, s[74:75]
    s_nop 1
    v_add_f32_dpp v4, v4, v4 quad_perm:[1,0,3,2] row_mask:0xf bank_mask:0xf
    s_nop 1
    v_add_f32_dpp v4, v4, v4 quad_perm:[2,3,0,1] row_mask:0xf bank_mask:0xf
    v_cvt_pk_bf16_f32 v32, v4, v4
    v_and_b32 v32, 0xffff0000, v32
    v_mfma_f32_16x16x32_bf16 v[24:27], v[72:75], v[8:11], 0
    v_mfma_f32_16x16x32_bf16 v[24:27], v[76:79], v[12:15], v[24:27]
    v_mfma_f32_16x16x32_bf16 v[24:27], v[80:83], v[16:19], v[24:27]
    v_mfma_f32_16x16x32_bf16 v[24:27], v[84:87], v[20:23], v[24:27]
    v_cndmask_b32 v4, v28, v29, s[70:71]
    v_cndmask_b32 v4, v4, v30, s[72:73]
    v_cndmask_b32 v4, v4, v31, s[74:75]
    s_nop 1
    v_add_f32_dpp v4, v4, v4 quad_perm:[1,0,3,2] row_mask:0xf bank_mask:0xf
    s_nop 1
    v_add_f32_dpp v4, v4, v4 quad_perm:[2,3,0,1] row_mask:0xf bank_mask:0xf
    v_cvt_pk_bf16_f32 v33, v4, v4
    v_and_b32 v33, 0xffff0000, v33
    s_waitcnt vmcnt(2)
    buffer_load_dwordx4 v[48:51], v2, s[44:47], s49 offen offset:2048 nt
    v_mfma_f32_16x16x32_bf16 v[28:31], v[88:91], v[8:11], 0
    v_mfma_f32_16x16x32_bf16 v[28:31], v[92:95], v[12:15], v[28:31]
    v_mfma_f32_16x16x32_bf16 v[28:31], v[96:99], v[16:19], v[28:31]
    v_mfma_f32_16x16x32_bf16 v[28:31], v[100:103], v[20:23], v[28:31]
    v_cndmask_b32 v4, v24, v25, s[70:71]
    v_cndmask_b32 v4, v4, v26, s[72:73]
    v_cndmask_b32 v4, v4, v27, s[74:75]
    s_nop 1
    v_add_f32_dpp v4, v4, v4 quad_perm:[1,0,3,2] row_mask:0xf bank_mask:0xf
    s_nop 1
    v_add_f32_dpp v4, v4, v4 quad_perm:[2,3,0,1] row_mask:0xf bank_mask:0xf
    v_cvt_pk_bf16_f32 v34, v4, v4
    v_and_b32 v34, 0xffff0000, v34
    v_mfma_f32_16x16x32_bf16 v[24:27], v[104:107], v[8:11], 0
    v_mfma_f32_16x16x32_bf16 v[24:27], v[108:111], v[12:15], v[24:27]
    v_mfma_f32_16x16x32_bf16 v[24:27], v[112:115], v[16:19], v[24:27]
    v_mfma_f32_16x16x32_bf16 v[24:27], v[116:119], v[20:23], v[24:27]
    v_cndmask_b32 v4, v28, v29, s[70:71]
    v_cndmask_b32 v4, v4, v30, s[72:73]
    v_cndmask_b32 v4, v4, v31, s[74:75]
    s_nop 1
    v_add_f32_dpp v4, v4, v4 quad_perm:[1,0,3,2] row_mask:0xf bank_mask:0xf
    s_nop 1
    v_add_f32_dpp v4, v4, v4 quad_perm:[2,3,0,1] row_mask:0xf bank_mask:0xf
    v_cvt_pk_bf16_f32 v35, v4, v4
    v_and_b32 v35, 0xffff0000, v35
    s_waitcnt vmcnt(2)
    buffer_load_dwordx4 v[52:55], v2, s[44:47], s49 offen offset:2304 nt
    v_mfma_f32_16x16x32_bf16 v[28:31], v[120:123], v[8:11], 0
    v_mfma_f32_16x16x32_bf16 v[28:31], v[124:127], v[12:15], v[28:31]
    v_mfma_f32_16x16x32_bf16 v[28:31], v[128:131], v[16:19], v[28:31]
    v_mfma_f32_16x16x32_bf16 v[28:31], v[132:135], v[20:23], v[28:31]
    v_cndmask_b32 v4, v24, v25, s[70:71]
    v_cndmask_b32 v4, v4, v26, s[72:73]
    v_cndmask_b32 v4, v4, v27, s[74:75]
    s_nop 1
    v_add_f32_dpp v4, v4, v4 quad_perm:[1,0,3,2] row_mask:0xf bank_mask:0xf
    s_nop 1
    v_add_f32_dpp v4, v4, v4 quad_perm:[2,3,0,1] row_mask:0xf bank_mask:0xf
    v_cvt_pk_bf16_f32 v36, v4, v4
    v_and_b32 v36, 0xffff0000, v36
    v_mfma_f32_16x16x32_bf16 v[24:27], v[136:139], v[8:11], 0
    v_mfma_f32_16x16x32_bf16 v[24:27], v[140:143], v[12:15], v[24:27]
    v_mfma_f32_16x16x32_bf16 v[24:27], v[144:147], v[16:19], v[24:27]
    v_mfma_f32_16x16x32_bf16 v[24:27], v[148:151], v[20:23], v[24:27]
    v_cndmask_b32 v4, v28, v29, s[70:71]
    v_cndmask_b32 v4, v4, v30, s[72:73]
    v_cndmask_b32 v4, v4, v31, s[74:75]
    s_nop 1
    v_add_f32_dpp v4, v4, v4 quad_perm:[1,0,3,2] row_mask:0xf bank_mask:0xf
    s_nop 1
    v_add_f32_dpp v4, v4, v4 quad_perm:[2,3,0,1] row_mask:0xf bank_mask:0xf
    v_cvt_pk_bf16_f32 v37, v4, v4
    v_and_b32 v37, 0xffff0000, v37
    s_waitcnt vmcnt(2)
    buffer_load_dwordx4 v[56:59], v2, s[44:47], s50 offen offset:0 nt
    v_mfma_f32_16x16x32_bf16 v[28:31], v[152:155], v[8:11], 0
    v_mfma_f32_16x16x32_bf16 v[28:31], v[156:159], v[12:15], v[28:31]
    v_mfma_f32_16x16x32_bf16 v[28:31], v[160:163], v[16:19], v[28:31]
    v_mfma_f32_16x16x32_bf16 v[28:31], v[164:167], v[20:23], v[28:31]
    v_cndmask_b32 v4, v24, v25, s[70:71]
    v_cndmask_b32 v4, v4, v26, s[72:73]
    v_cndmask_b32 v4, v4, v27, s[74:75]
    s_nop 1
    v_add_f32_dpp v4, v4, v4 quad_perm:[1,0,3,2] row_mask:0xf bank_mask:0xf
    s_nop 1
    v_add_f32_dpp v4, v4, v4 quad_perm:[2,3,0,1] row_mask:0xf bank_mask:0xf
    v_cvt_pk_bf16_f32 v38, v4, v4
    v_and_b32 v38, 0xffff0000, v38
    ds_read_b128 v[136:139], v5 offset:0
    ds_read_b128 v[140:143], v5 offset:1024
    ds_read_b128 v[144:147], v5 offset:2048
    ds_read_b128 v[148:151], v5 offset:3072
    s_waitcnt lgkmcnt(0)
    v_mfma_f32_16x16x32_bf16 v[24:27], v[136:139], v[8:11], 0
    v_mfma_f32_16x16x32_bf16 v[24:27], v[140:143], v[12:15], v[24:27]
    v_mfma_f32_16x16x32_bf16 v[24:27], v[144:147], v[16:19], v[24:27]
    v_mfma_f32_16x16x32_bf16 v[24:27], v[148:151], v[20:23], v[24:27]
    v_cndmask_b32 v4, v28, v29, s[70:71]
    v_cndmask_b32 v4, v4, v30, s[72:73]
    v_cndmask_b32 v4, v4, v31, s[74:75]
    s_nop 1
    v_add_f32_dpp v4, v4, v4 quad_perm:[1,0,3,2] row_mask:0xf bank_mask:0xf
    s_nop 1
    v_add_f32_dpp v4, v4, v4 quad_perm:[2,3,0,1] row_mask:0xf bank_mask:0xf
    v_cvt_pk_bf16_f32 v39, v4, v4
    v_and_b32 v39, 0xffff0000, v39
    s_waitcnt vmcnt(2)
    buffer_load_dwordx4 v[60:63], v2, s[44:47], s50 offen offset:256 nt
    v_cndmask_b32 v4, v24, v25, s[70:71]
    v_cndmask_b32 v4, v4, v26, s[72:73]
    v_cndmask_b32 v4, v4, v27, s[74:75]
    s_nop 1
    v_add_f32_dpp v4, v4, v4 quad_perm:[1,0,3,2] row_mask:0xf bank_mask:0xf
    s_nop 1
    v_add_f32_dpp v4, v4, v4 quad_perm:[2,3,0,1] row_mask:0xf bank_mask:0xf
    v_cvt_pk_bf16_f32 v20, v4, v4
    v_and_b32 v20, 0xffff0000, v20
    v_max3_f32 v8, v32, v33, v34
    v_max3_f32 v8, v8, v35, v36
    v_max3_f32 v8, v8, v37, v38
    v_max3_f32 v8, v8, v39, v20
    s_nop 1
    v_max_f32_dpp v8, v8, v8 row_ror:8 row_mask:0xf bank_mask:0xf
    v_mov_b32 v1, v8
    s_nop 1
    v_permlane16_swap_b32 v8, v1
    v_max_f32 v8, v8, v1
    v_mov_b32 v1, v8
    s_nop 1
    v_permlane32_swap_b32 v8, v1
    v_max_f32 v8, v8, v1
    v_mul_f32 v3, s78, v8
    v_fma_f32 v32, v32, s78, -v3
    v_fma_f32 v33, v33, s78, -v3
    v_fma_f32 v34, v34, s78, -v3
    v_fma_f32 v35, v35, s78, -v3
    v_fma_f32 v36, v36, s78, -v3
    v_fma_f32 v37, v37, s78, -v3
    v_fma_f32 v38, v38, s78, -v3
    v_fma_f32 v39, v39, s78, -v3
    v_fma_f32 v20, v20, s78, -v3
    v_exp_f32 v32, v32
    v_exp_f32 v33, v33
    v_exp_f32 v34, v34
    v_exp_f32 v35, v35
    v_exp_f32 v36, v36
    v_exp_f32 v37, v37
    v_exp_f32 v38, v38
    v_exp_f32 v39, v39
    v_exp_f32 v20, v20
    v_add_f32 v9, v32, v33
    v_add_f32 v9, v9, v34
    v_add_f32 v9, v9, v35
    v_add_f32 v9, v9, v36
    v_add_f32 v9, v9, v37
    v_add_f32 v9, v9, v38
    v_add_f32 v9, v9, v39
    v_add_f32 v9, v9, v20
    v_cvt_pk_bf16_f32 v32, v32, v32
    v_cvt_pk_bf16_f32 v33, v33, v33
    v_cvt_pk_bf16_f32 v34, v34, v34
    v_cvt_pk_bf16_f32 v35, v35, v35
    v_cvt_pk_bf16_f32 v36, v36, v36
    v_cvt_pk_bf16_f32 v37, v37, v37
    v_cvt_pk_bf16_f32 v38, v38, v38
    v_cvt_pk_bf16_f32 v39, v39, v39
    v_cvt_pk_bf16_f32 v20, v20, v20
    v_add_f32_dpp v9, v9, v9 row_ror:8 row_mask:0xf bank_mask:0xf
    v_mov_b32 v3, v9
    s_nop 1
    v_permlane16_swap_b32 v9, v3
    v_add_f32 v9, v9, v3
    v_mov_b32 v3, v9
    s_nop 1
    v_permlane32_swap_b32 v9, v3
    v_add_f32 v9, v9, v3
    v_bfe_u32 v3, v0, 2, 1
    v_lshlrev_b32 v3, 3, v3
    s_lshl_b32 s9, s3, 4
    v_add_u32 v3, s9, v3
    ds_write_b64 v3, v[8:9] offset:1792
    v_mov_b32 v1, 1
    s_mov_b64 exec, 1
    ds_add_u32 v6, v1 offset:4
    s_mov_b64 exec, -1
    v_bfe_u32 v1, v0, 3, 1
    v_and_b32 v3, 3, v0
    v_lshl_add_u32 v1, v1, 2, v3
    v_mov_b32 v23, v5
    v_and_b32 v24, 1, v1
    v_lshlrev_b32 v24, 4, v24
    v_mov_b32 v25, 0xffff
    v_lshlrev_b32 v24, v24, v25
    v_lshrrev_b32 v25, 1, v1
    v_cmp_eq_u32 vcc, 0, v25
    s_nop 1
    v_cndmask_b32 v4, 0, v24, vcc
    v_cmp_eq_u32 vcc, 1, v25
    s_nop 1
    v_cndmask_b32 v5, 0, v24, vcc
    v_cmp_eq_u32 vcc, 2, v25
    s_nop 1
    v_cndmask_b32 v6, 0, v24, vcc
    v_cmp_eq_u32 vcc, 3, v25
    s_nop 1
    v_cndmask_b32 v7, 0, v24, vcc
    v_lshlrev_b32 v21, 4, v0
    s_lshl_b32 s9, s3, 11
    v_add_u32 v21, s9, v21
    s_waitcnt lgkmcnt(0)
    v_mov_b32_dpp v1, v32 row_ror:8 row_mask:0xf bank_mask:0xf
    v_cndmask_b32 v1, v32, v1, s[76:77]
    v_and_b32 v8, v1, v4
    v_and_b32 v9, v1, v5
    v_and_b32 v10, v1, v6
    v_and_b32 v11, v1, v7
    s_waitcnt vmcnt(2)
    buffer_load_dwordx4 v[64:67], v2, s[44:47], s50 offen offset:2048 nt
    ds_read_b128 v[152:155], v23 offset:4096
    ds_read_b128 v[156:159], v23 offset:5120
    ds_read_b128 v[160:163], v23 offset:6144
    ds_read_b128 v[164:167], v23 offset:7168
    s_waitcnt lgkmcnt(0)
    v_mov_b32_dpp v1, v32 row_ror:8 row_mask:0xf bank_mask:0xf
    v_cndmask_b32 v1, v1, v32, s[76:77]
    v_and_b32 v12, v1, v4
    v_and_b32 v13, v1, v5
    v_and_b32 v14, v1, v6
    v_and_b32 v15, v1, v7
    v_mfma_f32_16x16x32_bf16 v[24:27], v[8:11], v[152:155], 0
    v_mfma_f32_16x16x32_bf16 v[28:31], v[8:11], v[156:159], 0
    v_mov_b32_dpp v1, v33 row_ror:8 row_mask:0xf bank_mask:0xf
    v_cndmask_b32 v1, v33, v1, s[76:77]
    v_and_b32 v16, v1, v4
    v_and_b32 v17, v1, v5
    v_and_b32 v18, v1, v6
    v_and_b32 v19, v1, v7
    v_mfma_f32_16x16x32_bf16 v[24:27], v[12:15], v[160:163], v[24:27]
    s_waitcnt vmcnt(2)
    buffer_load_dwordx4 v[68:71], v2, s[44:47], s50 offen offset:2304 nt
    v_mfma_f32_16x16x32_bf16 v[28:31], v[12:15], v[164:167], v[28:31]
    v_mov_b32_dpp v1, v33 row_ror:8 row_mask:0xf bank_mask:0xf
    v_cndmask_b32 v1, v1, v33, s[76:77]
    v_and_b32 v8, v1, v4
    v_and_b32 v9, v1, v5
    v_and_b32 v10, v1, v6
    v_and_b32 v11, v1, v7
    v_mfma_f32_16x16x32_bf16 v[24:27], v[16:19], v[40:43], v[24:27]
    v_mfma_f32_16x16x32_bf16 v[28:31], v[16:19], v[44:47], v[28:31]
    s_waitcnt vmcnt(2)
    buffer_load_dwordx4 v[72:75], v2, s[44:47], s51 offen offset:0 nt
    v_mov_b32_dpp v1, v34 row_ror:8 row_mask:0xf bank_mask:0xf
    v_cndmask_b32 v1, v34, v1, s[76:77]
    v_and_b32 v12, v1, v4
    v_and_b32 v13, v1, v5
    v_and_b32 v14, v1, v6
    v_and_b32 v15, v1, v7
    v_mfma_f32_16x16x32_bf16 v[24:27], v[8:11], v[48:51], v[24:27]
    v_mfma_f32_16x16x32_bf16 v[28:31], v[8:11], v[52:55], v[28:31]
    v_mov_b32_dpp v1, v34 row_ror:8 row_mask:0xf bank_mask:0xf
    v_cndmask_b32 v1, v1, v34, s[76:77]
    v_and_b32 v16, v1, v4
    v_and_b32 v17, v1, v5
    v_and_b32 v18, v1, v6
    v_and_b32 v19, v1, v7
    v_mfma_f32_16x16x32_bf16 v[24:27], v[12:15], v[56:59], v[24:27]
    s_waitcnt vmcnt(2)
    buffer_load_dwordx4 v[76:79], v2, s[44:47], s51 offen offset:256 nt
    v_mfma_f32_16x16x32_bf16 v[28:31], v[12:15], v[60:63], v[28:31]
    v_mov_b32_dpp v1, v35 row_ror:8 row_mask:0xf bank_mask:0xf
    v_cndmask_b32 v1, v35, v1, s[76:77]
    v_and_b32 v8, v1, v4
    v_and_b32 v9, v1, v5
    v_and_b32 v10, v1, v6
    v_and_b32 v11, v1, v7
    v_mfma_f32_16x16x32_bf16 v[24:27], v[16:19], v[64:67], v[24:27]
    s_waitcnt vmcnt(2)
    buffer_load_dwordx4 v[80:83], v2, s[44:47], s51 offen offset:2048 nt
    v_mfma_f32_16x16x32_bf16 v[28:31], v[16:19], v[68:71], v[28:31]
    s_waitcnt vmcnt(2)
    buffer_load_dwordx4 v[84:87], v2, s[44:47], s51 offen offset:2304 nt
    v_mov_b32_dpp v1, v35 row_ror:8 row_mask:0xf bank_mask:0xf
    v_cndmask_b32 v1, v1, v35, s[76:77]
    v_and_b32 v12, v1, v4
    v_and_b32 v13, v1, v5
    v_and_b32 v14, v1, v6
    v_and_b32 v15, v1, v7
    v_mfma_f32_16x16x32_bf16 v[24:27], v[8:11], v[72:75], v[24:27]
    s_waitcnt vmcnt(2)
    buffer_load_dwordx4 v[88:91], v2, s[44:47], s52 offen offset:0 nt
    v_mfma_f32_16x16x32_bf16 v[28:31], v[8:11], v[76:79], v[28:31]
    s_waitcnt vmcnt(2)
    buffer_load_dwordx4 v[92:95], v2, s[44:47], s52 offen offset:256 nt
    v_mov_b32_dpp v1, v36 row_ror:8 row_mask:0xf bank_mask:0xf
    v_cndmask_b32 v1, v36, v1, s[76:77]
    v_and_b32 v16, v1, v4
    v_and_b32 v17, v1, v5
    v_and_b32 v18, v1, v6
    v_and_b32 v19, v1, v7
    v_mfma_f32_16x16x32_bf16 v[24:27], v[12:15], v[80:83], v[24:27]
    s_waitcnt vmcnt(2)
    buffer_load_dwordx4 v[96:99], v2, s[44:47], s52 offen offset:2048 nt
    v_mfma_f32_16x16x32_bf16 v[28:31], v[12:15], v[84:87], v[28:31]
    s_waitcnt vmcnt(2)
    buffer_load_dwordx4 v[100:103], v2, s[44:47], s52 offen offset:2304 nt
    v_mov_b32_dpp v1, v36 row_ror:8 row_mask:0xf bank_mask:0xf
    v_cndmask_b32 v1, v1, v36, s[76:77]
    v_and_b32 v8, v1, v4
    v_and_b32 v9, v1, v5
    v_and_b32 v10, v1, v6
    v_and_b32 v11, v1, v7
    v_mfma_f32_16x16x32_bf16 v[24:27], v[16:19], v[88:91], v[24:27]
    s_waitcnt vmcnt(2)
    buffer_load_dwordx4 v[104:107], v2, s[44:47], s53 offen offset:0 nt
    v_mfma_f32_16x16x32_bf16 v[28:31], v[16:19], v[92:95], v[28:31]
    s_waitcnt vmcnt(2)
    buffer_load_dwordx4 v[108:111], v2, s[44:47], s53 offen offset:256 nt
    v_mov_b32_dpp v1, v37 row_ror:8 row_mask:0xf bank_mask:0xf
    v_cndmask_b32 v1, v37, v1, s[76:77]
    v_and_b32 v12, v1, v4
    v_and_b32 v13, v1, v5
    v_and_b32 v14, v1, v6
    v_and_b32 v15, v1, v7
    v_mfma_f32_16x16x32_bf16 v[24:27], v[8:11], v[96:99], v[24:27]
    s_waitcnt vmcnt(2)
    buffer_load_dwordx4 v[112:115], v2, s[44:47], s53 offen offset:2048 nt
    v_mfma_f32_16x16x32_bf16 v[28:31], v[8:11], v[100:103], v[28:31]
    s_waitcnt vmcnt(2)
    buffer_load_dwordx4 v[116:119], v2, s[44:47], s53 offen offset:2304 nt
    v_mov_b32_dpp v1, v37 row_ror:8 row_mask:0xf bank_mask:0xf
    v_cndmask_b32 v1, v1, v37, s[76:77]
    v_and_b32 v16, v1, v4
    v_and_b32 v17, v1, v5
    v_and_b32 v18, v1, v6
    v_and_b32 v19, v1, v7
    v_mfma_f32_16x16x32_bf16 v[24:27], v[12:15], v[104:107], v[24:27]
    s_waitcnt vmcnt(2)
    buffer_load_dwordx4 v[120:123], v2, s[44:47], s54 offen offset:0 nt
    v_mfma_f32_16x16x32_bf16 v[28:31], v[12:15], v[108:111], v[28:31]
    s_waitcnt vmcnt(2)
    buffer_load_dwordx4 v[124:127], v2, s[44:47], s54 offen offset:256 nt
    v_mov_b32_dpp v1, v38 row_ror:8 row_mask:0xf bank_mask:0xf
    v_cndmask_b32 v1, v38, v1, s[76:77]
    v_and_b32 v8, v1, v4
    v_and_b32 v9, v1, v5
    v_and_b32 v10, v1, v6
    v_and_b32 v11, v1, v7
    v_mfma_f32_16x16x32_bf16 v[24:27], v[16:19], v[112:115], v[24:27]
    s_waitcnt vmcnt(2)
    buffer_load_dwordx4 v[128:131], v2, s[44:47], s54 offen offset:2048 nt
    v_mfma_f32_16x16x32_bf16 v[28:31], v[16:19], v[116:119], v[28:31]
    s_waitcnt vmcnt(2)
    buffer_load_dwordx4 v[132:135], v2, s[44:47], s54 offen offset:2304 nt
    v_mov_b32_dpp v1, v38 row_ror:8 row_mask:0xf bank_mask:0xf
    v_cndmask_b32 v1, v1, v38, s[76:77]
    v_and_b32 v12, v1, v4
    v_and_b32 v13, v1, v5
    v_and_b32 v14, v1, v6
    v_and_b32 v15, v1, v7
    v_mfma_f32_16x16x32_bf16 v[24:27], v[8:11], v[120:123], v[24:27]
    s_waitcnt vmcnt(2)
    buffer_load_dwordx4 v[136:139], v2, s[44:47], s55 offen offset:0 nt
    v_mfma_f32_16x16x32_bf16 v[28:31], v[8:11], v[124:127], v[28:31]
    s_waitcnt vmcnt(2)
    buffer_load_dwordx4 v[140:143], v2, s[44:47], s55 offen offset:256 nt
    v_mov_b32_dpp v1, v39 row_ror:8 row_mask:0xf bank_mask:0xf
    v_cndmask_b32 v1, v39, v1, s[76:77]
    v_and_b32 v16, v1, v4
    v_and_b32 v17, v1, v5
    v_and_b32 v18, v1, v6
    v_and_b32 v19, v1, v7
    v_mfma_f32_16x16x32_bf16 v[24:27], v[12:15], v[128:131], v[24:27]
    s_waitcnt vmcnt(2)
    buffer_load_dwordx4 v[144:147], v2, s[44:47], s55 offen offset:2048 nt
    v_mfma_f32_16x16x32_bf16 v[28:31], v[12:15], v[132:135], v[28:31]
    buffer_load_dwordx4 v[148:151], v2, s[44:47], s55 offen offset:2304 nt
    buffer_load_dwordx4 v[152:155], v2, s[44:47], s56 offen offset:0 nt
    buffer_load_dwordx4 v[156:159], v2, s[44:47], s56 offen offset:256 nt
    buffer_load_dwordx4 v[160:163], v2, s[44:47], s56 offen offset:2048 nt
    buffer_load_dwordx4 v[164:167], v2, s[44:47], s56 offen offset:2304 nt
    s_waitcnt vmcnt(7)
    v_mov_b32_dpp v1, v39 row_ror:8 row_mask:0xf bank_mask:0xf
    v_cndmask_b32 v1, v1, v39, s[76:77]
    v_and_b32 v8, v1, v4
    v_and_b32 v9, v1, v5
    v_and_b32 v10, v1, v6
    v_and_b32 v11, v1, v7
    v_mfma_f32_16x16x32_bf16 v[24:27], v[16:19], v[136:139], v[24:27]
    s_waitcnt vmcnt(6)
    v_mfma_f32_16x16x32_bf16 v[28:31], v[16:19], v[140:143], v[28:31]
    s_waitcnt vmcnt(5)
    v_mov_b32_dpp v1, v20 row_ror:8 row_mask:0xf bank_mask:0xf
    v_cndmask_b32 v1, v20, v1, s[76:77]
    v_and_b32 v12, v1, v4
    v_and_b32 v13, v1, v5
    v_and_b32 v14, v1, v6
    v_and_b32 v15, v1, v7
    v_mfma_f32_16x16x32_bf16 v[24:27], v[8:11], v[144:147], v[24:27]
    s_waitcnt vmcnt(4)
    v_mfma_f32_16x16x32_bf16 v[28:31], v[8:11], v[148:151], v[28:31]
    s_waitcnt vmcnt(3)
    v_mov_b32_dpp v1, v20 row_ror:8 row_mask:0xf bank_mask:0xf
    v_cndmask_b32 v1, v1, v20, s[76:77]
    v_and_b32 v16, v1, v4
    v_and_b32 v17, v1, v5
    v_and_b32 v18, v1, v6
    v_and_b32 v19, v1, v7
    v_mfma_f32_16x16x32_bf16 v[24:27], v[12:15], v[152:155], v[24:27]
    s_waitcnt vmcnt(2)
    v_mfma_f32_16x16x32_bf16 v[28:31], v[12:15], v[156:159], v[28:31]
    s_waitcnt vmcnt(1)
    v_mfma_f32_16x16x32_bf16 v[24:27], v[16:19], v[160:163], v[24:27]
    s_waitcnt vmcnt(0)
    v_mfma_f32_16x16x32_bf16 v[28:31], v[16:19], v[164:167], v[28:31]
    s_nop 7
    s_branch L_sfin
L_body164:
    buffer_load_dwordx4 v[52:55], v1, s[40:43], s48 offen offset:384 nt
    s_waitcnt vmcnt(3)
    buffer_load_dwordx4 v[56:59], v1, s[40:43], s49 offen offset:0 nt
    s_waitcnt vmcnt(3)
    buffer_load_dwordx4 v[60:63], v1, s[40:43], s49 offen offset:128 nt
    s_waitcnt vmcnt(3)
    buffer_load_dwordx4 v[64:67], v1, s[40:43], s49 offen offset:256 nt
    s_waitcnt vmcnt(3)
    buffer_load_dwordx4 v[68:71], v1, s[40:43], s49 offen offset:384 nt
    s_waitcnt vmcnt(3)
    buffer_load_dwordx4 v[72:75], v1, s[40:43], s50 offen offset:0 nt
    s_waitcnt vmcnt(3)
    buffer_load_dwordx4 v[76:79], v1, s[40:43], s50 offen offset:128 nt
    s_waitcnt vmcnt(3)
    buffer_load_dwordx4 v[80:83], v1, s[40:43], s50 offen offset:256 nt
    s_waitcnt vmcnt(3)
    buffer_load_dwordx4 v[84:87], v1, s[40:43], s50 offen offset:384 nt
    s_waitcnt vmcnt(3)
    buffer_load_dwordx4 v[88:91], v1, s[40:43], s51 offen offset:0 nt
    s_waitcnt vmcnt(3)
    buffer_load_dwordx4 v[92:95], v1, s[40:43], s51 offen offset:128 nt
    s_waitcnt vmcnt(3)
    buffer_load_dwordx4 v[96:99], v1, s[40:43], s51 offen offset:256 nt
    s_waitcnt vmcnt(3)
    buffer_load_dwordx4 v[100:103], v1, s[40:43], s51 offen offset:384 nt
    s_waitcnt vmcnt(3)
    buffer_load_dwordx4 v[104:107], v1, s[40:43], s52 offen offset:0 nt
    s_waitcnt vmcnt(3)
    buffer_load_dwordx4 v[108:111], v1, s[40:43], s52 offen offset:128 nt
    s_waitcnt vmcnt(3)
    buffer_load_dwordx4 v[112:115], v1, s[40:43], s52 offen offset:256 nt
    s_waitcnt vmcnt(3)
    buffer_load_dwordx4 v[116:119], v1, s[40:43], s52 offen offset:384 nt
    s_waitcnt vmcnt(3)
    buffer_load_dwordx4 v[120:123], v1, s[40:43], s53 offen offset:0 nt
    s_waitcnt vmcnt(3)
    buffer_load_dwordx4 v[124:127], v1, s[40:43], s53 offen offset:128 nt
    s_waitcnt vmcnt(3)
    buffer_load_dwordx4 v[128:131], v1, s[40:43], s53 offen offset:256 nt
    s_waitcnt vmcnt(3)
    buffer_load_dwordx4 v[132:135], v1, s[40:43], s53 offen offset:384 nt
    s_waitcnt vmcnt(3)
    buffer_load_dwordx4 v[136:139], v1, s[40:43], s54 offen offset:0 nt
    s_waitcnt vmcnt(3)
    buffer_load_dwordx4 v[140:143], v1, s[40:43], s54 offen offset:128 nt
    s_waitcnt vmcnt(3)
    buffer_load_dwordx4 v[144:147], v1, s[40:43], s54 offen offset:256 nt
    s_waitcnt vmcnt(3)
    buffer_load_dwordx4 v[148:151], v1, s[40:43], s54 offen offset:384 nt
    s_waitcnt vmcnt(3)
    buffer_load_dwordx4 v[152:155], v1, s[40:43], s55 offen offset:0 nt
    s_waitcnt vmcnt(3)
    buffer_load_dwordx4 v[156:159], v1, s[40:43], s55 offen offset:128 nt
    s_waitcnt vmcnt(3)
    buffer_load_dwordx4 v[160:163], v1, s[40:43], s55 offen offset:256 nt
    v_mov_b32 v4, 1
    s_mov_b64 exec, 1
    ds_add_u32 v6, v4 offset:12
    s_mov_b64 exec, -1
    s_waitcnt vmcnt(3)
    buffer_load_dwordx4 v[164:167], v1, s[40:43], s55 offen offset:384 nt
    s_waitcnt vmcnt(3)
    s_add_u32 m0, s58, 0
    s_nop 0
    buffer_load_dwordx4 v1, s[40:43], s56 offen offset:0 nt lds
    s_waitcnt vmcnt(3)
    s_add_u32 m0, s58, 896
    s_nop 0
    buffer_load_dwordx4 v1, s[40:43], s56 offen offset:128 nt lds
    s_waitcnt vmcnt(3)
    s_add_u32 m0, s58, 1792
    s_nop 0
    buffer_load_dwordx4 v1, s[40:43], s56 offen offset:256 nt lds
    s_waitcnt vmcnt(3)
    s_add_u32 m0, s58, 2688
    s_nop 0
    buffer_load_dwordx4 v1, s[40:43], s56 offen offset:384 nt lds
    s_waitcnt vmcnt(3)
    s_add_u32 m0, s58, 4096
    s_nop 0
    buffer_load_dwordx4 v1, s[40:43], s57 offen offset:0 nt lds
    s_waitcnt vmcnt(3)
    s_add_u32 m0, s58, 4992
    s_nop 0
    buffer_load_dwordx4 v1, s[40:43], s57 offen offset:128 nt lds
    s_waitcnt vmcnt(3)
    s_add_u32 m0, s58, 5888
    s_nop 0
    buffer_load_dwordx4 v1, s[40:43], s57 offen offset:256 nt lds
    s_waitcnt vmcnt(3)
    s_add_u32 m0, s58, 6784
    s_nop 0
    buffer_load_dwordx4 v1, s[40:43], s57 offen offset:384 nt lds
    s_waitcnt vmcnt(3)
    s_mov_b32 s10, 0x30d400
L_lw_3:
    ds_read_b32 v4, v6 offset:0
    s_waitcnt lgkmcnt(0)
    v_readfirstlane_b32 s9, v4
    s_nop 0
    s_cmp_ge_u32 s9, 1
    s_cbranch_scc1 L_lwd_4
    s_sleep 2
    s_sub_u32 s10, s10, 1
    s_cbranch_scc0 L_lw_3
L_lwd_4:
    ds_read_b128 v[8:11], v3 offset:256
    ds_read_b128 v[12:15], v3 offset:384
    ds_read_b128 v[16:19], v3 offset:512
    ds_read_b128 v[20:23], v3 offset:640
    s_waitcnt lgkmcnt(0)
    v_mfma_f32_16x16x32_bf16 v[24:27], v[40:43], v[8:11], 0
    v_mfma_f32_16x16x32_bf16 v[24:27], v[44:47], v[12:15], v[24:27]
    v_mfma_f32_16x16x32_bf16 v[24:27], v[48:51], v[16:19], v[24:27]
    v_mfma_f32_16x16x32_bf16 v[24:27], v[52:55], v[20:23], v[24:27]
    buffer_load_dwordx4 v[40:43], v2, s[44:47], s48 offen offset:0 nt
    s_waitcnt vmcnt(3)
    buffer_load_dwordx4 v[44:47], v2, s[44:47], s48 offen offset:256 nt
    v_mfma_f32_16x16x32_bf16 v[28:31], v[56:59], v[8:11], 0
    v_mfma_f32_16x16x32_bf16 v[28:31], v[60:63], v[12:15], v[28:31]
    v_mfma_f32_16x16x32_bf16 v[28:31], v[64:67], v[16:19], v[28:31]
    v_mfma_f32_16x16x32_bf16 v[28:31], v[68:71], v[20:23], v[28:31]
    s_nop 0
    v_cndmask_b32 v4, v24, v25, s[70:71]
    v_cndmask_b32 v4, v4, v26, s[72:73]
    v_cndmask_b32 v4, v4, v27, s[74:75]
    s_nop 1
    v_add_f32_dpp v4, v4, v4 quad_perm:[1,0,3,2] row_mask:0xf bank_mask:0xf
    s_nop 1
    v_add_f32_dpp v4, v4, v4 quad_perm:[2,3,0,1] row_mask:0xf bank_mask:0xf
    v_cvt_pk_bf16_f32 v32, v4, v4
    v_and_b32 v32, 0xffff0000, v32
    v_mfma_f32_16x16x32_bf16 v[24:27], v[72:75], v[8:11], 0
    v_mfma_f32_16x16x32_bf16 v[24:27], v[76:79], v[12:15], v[24:27]
    v_mfma_f32_16x16x32_bf16 v[24:27], v[80:83], v[16:19], v[24:27]
    v_mfma_f32_16x16x32_bf16 v[24:27], v[84:87], v[20:23], v[24:27]
    v_cndmask_b32 v4, v28, v29, s[70:71]
    v_cndmask_b32 v4, v4, v30, s[72:73]
    v_cndmask_b32 v4, v4, v31, s[74:75]
    s_nop 1
    v_add_f32_dpp v4, v4, v4 quad_perm:[1,0,3,2] row_mask:0xf bank_mask:0xf
    s_nop 1
    v_add_f32_dpp v4, v4, v4 quad_perm:[2,3,0,1] row_mask:0xf bank_mask:0xf
    v_cvt_pk_bf16_f32 v33, v4, v4
    v_and_b32 v33, 0xffff0000, v33
    s_waitcnt vmcnt(3)
    buffer_load_dwordx4 v[48:51], v2, s[44:47], s48 offen offset:2048 nt
    v_mfma_f32_16x16x32_bf16 v[28:31], v[88:91], v[8:11], 0
    v_mfma_f32_16x16x32_bf16 v[28:31], v[92:95], v[12:15], v[28:31]
    v_mfma_f32_16x16x32_bf16 v[28:31], v[96:99], v[16:19], v[28:31]
    v_mfma_f32_16x16x32_bf16 v[28:31], v[100:103], v[20:23], v[28:31]
    v_cndmask_b32 v4, v24, v25, s[70:71]
    v_cndmask_b32 v4, v4, v26, s[72:73]
    v_cndmask_b32 v4, v4, v27, s[74:75]
    s_nop 1
    v_add_f32_dpp v4, v4, v4 quad_perm:[1,0,3,2] row_mask:0xf bank_mask:0xf
    s_nop 1
    v_add_f32_dpp v4, v4, v4 quad_perm:[2,3,0,1] row_mask:0xf bank_mask:0xf
    v_cvt_pk_bf16_f32 v34, v4, v4
    v_and_b32 v34, 0xffff0000, v34
    v_mfma_f32_16x16x32_bf16 v[24:27], v[104:107], v[8:11], 0
    v_mfma_f32_16x16x32_bf16 v[24:27], v[108:111], v[12:15], v[24:27]
    v_mfma_f32_16x16x32_bf16 v[24:27], v[112:115], v[16:19], v[24:27]
    v_mfma_f32_16x16x32_bf16 v[24:27], v[116:119], v[20:23], v[24:27]
    v_cndmask_b32 v4, v28, v29, s[70:71]
    v_cndmask_b32 v4, v4, v30, s[72:73]
    v_cndmask_b32 v4, v4, v31, s[74:75]
    s_nop 1
    v_add_f32_dpp v4, v4, v4 quad_perm:[1,0,3,2] row_mask:0xf bank_mask:0xf
    s_nop 1
    v_add_f32_dpp v4, v4, v4 quad_perm:[2,3,0,1] row_mask:0xf bank_mask:0xf
    v_cvt_pk_bf16_f32 v35, v4, v4
    v_and_b32 v35, 0xffff0000, v35
    s_waitcnt vmcnt(3)
    buffer_load_dwordx4 v[52:55], v2, s[44:47], s48 offen offset:2304 nt
    v_mfma_f32_16x16x32_bf16 v[28:31], v[120:123], v[8:11], 0
    v_mfma_f32_16x16x32_bf16 v[28:31], v[124:127], v[12:15], v[28:31]
    v_mfma_f32_16x16x32_bf16 v[28:31], v[128:131], v[16:19], v[28:31]
    v_mfma_f32_16x16x32_bf16 v[28:31], v[132:135], v[20:23], v[28:31]
    v_cndmask_b32 v4, v24, v25, s[70:71]
    v_cndmask_b32 v4, v4, v26, s[72:73]
    v_cndmask_b32 v4, v4, v27, s[74:75]
    s_nop 1
    v_add_f32_dpp v4, v4, v4 quad_perm:[1,0,3,2] row_mask:0xf bank_mask:0xf
    s_nop 1
    v_add_f32_dpp v4, v4, v4 quad_perm:[2,3,0,1] row_mask:0xf bank_mask:0xf
    v_cvt_pk_bf16_f32 v36, v4, v4
    v_and_b32 v36, 0xffff0000, v36
    v_mfma_f32_16x16x32_bf16 v[24:27], v[136:139], v[8:11], 0
    v_mfma_f32_16x16x32_bf16 v[24:27], v[140:143], v[12:15], v[24:27]
    v_mfma_f32_16x16x32_bf16 v[24:27], v[144:147], v[16:19], v[24:27]
    v_mfma_f32_16x16x32_bf16 v[24:27], v[148:151], v[20:23], v[24:27]
    v_cndmask_b32 v4, v28, v29, s[70:71]
    v_cndmask_b32 v4, v4, v30, s[72:73]
    v_cndmask_b32 v4, v4, v31, s[74:75]
    s_nop 1
    v_add_f32_dpp v4, v4, v4 quad_perm:[1,0,3,2] row_mask:0xf bank_mask:0xf
    s_nop 1
    v_add_f32_dpp v4, v4, v4 quad_perm:[2,3,0,1] row_mask:0xf bank_mask:0xf
    v_cvt_pk_bf16_f32 v37, v4, v4
    v_and_b32 v37, 0xffff0000, v37
    s_waitcnt vmcnt(3)
    buffer_load_dwordx4 v[56:59], v2, s[44:47], s49 offen offset:0 nt
    v_mfma_f32_16x16x32_bf16 v[28:31], v[152:155], v[8:11], 0
    v_mfma_f32_16x16x32_bf16 v[28:31], v[156:159], v[12:15], v[28:31]
    v_mfma_f32_16x16x32_bf16 v[28:31], v[160:163], v[16:19], v[28:31]
    v_mfma_f32_16x16x32_bf16 v[28:31], v[164:167], v[20:23], v[28:31]
    v_cndmask_b32 v4, v24, v25, s[70:71]
    v_cndmask_b32 v4, v4, v26, s[72:73]
    v_cndmask_b32 v4, v4, v27, s[74:75]
    s_nop 1
    v_add_f32_dpp v4, v4, v4 quad_perm:[1,0,3,2] row_mask:0xf bank_mask:0xf
    s_nop 1
    v_add_f32_dpp v4, v4, v4 quad_perm:[2,3,0,1] row_mask:0xf bank_mask:0xf
    v_cvt_pk_bf16_f32 v38, v4, v4
    v_and_b32 v38, 0xffff0000, v38
    ds_read_b128 v[136:139], v5 offset:0
    ds_read_b128 v[140:143], v5 offset:1024
    ds_read_b128 v[144:147], v5 offset:2048
    ds_read_b128 v[148:151], v5 offset:3072
    s_waitcnt lgkmcnt(0)
    v_mfma_f32_16x16x32_bf16 v[24:27], v[136:139], v[8:11], 0
    v_mfma_f32_16x16x32_bf16 v[24:27], v[140:143], v[12:15], v[24:27]
    v_mfma_f32_16x16x32_bf16 v[24:27], v[144:147], v[16:19], v[24:27]
    v_mfma_f32_16x16x32_bf16 v[24:27], v[148:151], v[20:23], v[24:27]
    v_cndmask_b32 v4, v28, v29, s[70:71]
    v_cndmask_b32 v4, v4, v30, s[72:73]
    v_cndmask_b32 v4, v4, v31, s[74:75]
    s_nop 1
    v_add_f32_dpp v4, v4, v4 quad_perm:[1,0,3,2] row_mask:0xf bank_mask:0xf
    s_nop 1
    v_add_f32_dpp v4, v4, v4 quad_perm:[2,3,0,1] row_mask:0xf bank_mask:0xf
    v_cvt_pk_bf16_f32 v39, v4, v4
    v_and_b32 v39, 0xffff0000, v39
    s_waitcnt vmcnt(3)
    buffer_load_dwordx4 v[60:63], v2, s[44:47], s49 offen offset:256 nt
    ds_read_b128 v[152:155], v5 offset:4096
    ds_read_b128 v[156:159], v5 offset:5120
    ds_read_b128 v[160:163], v5 offset:6144
    ds_read_b128 v[164:167], v5 offset:7168
    s_waitcnt lgkmcnt(0)
    v_mfma_f32_16x16x32_bf16 v[28:31], v[152:155], v[8:11], 0
    v_mfma_f32_16x16x32_bf16 v[28:31], v[156:159], v[12:15], v[28:31]
    v_mfma_f32_16x16x32_bf16 v[28:31], v[160:163], v[16:19], v[28:31]
    v_mfma_f32_16x16x32_bf16 v[28:31], v[164:167], v[20:23], v[28:31]
    v_cndmask_b32 v4, v24, v25, s[70:71]
    v_cndmask_b32 v4, v4, v26, s[72:73]
    v_cndmask_b32 v4, v4, v27, s[74:75]
    s_nop 1
    v_add_f32_dpp v4, v4, v4 quad_perm:[1,0,3,2] row_mask:0xf bank_mask:0xf
    s_nop 1
    v_add_f32_dpp v4, v4, v4 quad_perm:[2,3,0,1] row_mask:0xf bank_mask:0xf
    v_cvt_pk_bf16_f32 v20, v4, v4
    v_and_b32 v20, 0xffff0000, v20
    s_waitcnt vmcnt(3)
    buffer_load_dwordx4 v[64:67], v2, s[44:47], s49 offen offset:2048 nt
    v_cndmask_b32 v4, v28, v29, s[70:71]
    v_cndmask_b32 v4, v4, v30, s[72:73]
    v_cndmask_b32 v4, v4, v31, s[74:75]
    s_nop 1
    v_add_f32_dpp v4, v4, v4 quad_perm:[1,0,3,2] row_mask:0xf bank_mask:0xf
    s_nop 1
    v_add_f32_dpp v4, v4, v4 quad_perm:[2,3,0,1] row_mask:0xf bank_mask:0xf
    v_cvt_pk_bf16_f32 v22, v4, v4
    v_and_b32 v22, 0xffff0000, v22
    v_max3_f32 v8, v32, v33, v34
    v_max3_f32 v8, v8, v35, v36
    v_max3_f32 v8, v8, v37, v38
    v_max3_f32 v8, v8, v39, v20
    v_max_f32 v8, v8, v22
    s_nop 1
    v_max_f32_dpp v8, v8, v8 row_ror:8 row_mask:0xf bank_mask:0xf
    v_mov_b32 v1, v8
    s_nop 1
    v_permlane16_swap_b32 v8, v1
    v_max_f32 v8, v8, v1
    v_mov_b32 v1, v8
    s_nop 1
    v_permlane32_swap_b32 v8, v1
    v_max_f32 v8, v8, v1
    v_mul_f32 v3, s78, v8
    v_fma_f32 v32, v32, s78, -v3
    v_fma_f32 v33, v33, s78, -v3
    v_fma_f32 v34, v34, s78, -v3
    v_fma_f32 v35, v35, s78, -v3
    v_fma_f32 v36, v36, s78, -v3
    v_fma_f32 v37, v37, s78, -v3
    v_fma_f32 v38, v38, s78, -v3
    v_fma_f32 v39, v39, s78, -v3
    v_fma_f32 v20, v20, s78, -v3
    v_fma_f32 v22, v22, s78, -v3
    v_exp_f32 v32, v32
    v_exp_f32 v33, v33
    v_exp_f32 v34, v34
    v_exp_f32 v35, v35
    v_exp_f32 v36, v36
    v_exp_f32 v37, v37
    v_exp_f32 v38, v38
    v_exp_f32 v39, v39
    v_exp_f32 v20, v20
    v_exp_f32 v22, v22
    v_add_f32 v9, v32, v33
    v_add_f32 v9, v9, v34
    v_add_f32 v9, v9, v35
    v_add_f32 v9, v9, v36
    v_add_f32 v9, v9, v37
    v_add_f32 v9, v9, v38
    v_add_f32 v9, v9, v39
    v_add_f32 v9, v9, v20
    v_add_f32 v9, v9, v22
    v_cvt_pk_bf16_f32 v32, v32, v32
    v_cvt_pk_bf16_f32 v33, v33, v33
    v_cvt_pk_bf16_f32 v34, v34, v34
    v_cvt_pk_bf16_f32 v35, v35, v35
    v_cvt_pk_bf16_f32 v36, v36, v36
    v_cvt_pk_bf16_f32 v37, v37, v37
    v_cvt_pk_bf16_f32 v38, v38, v38
    v_cvt_pk_bf16_f32 v39, v39, v39
    v_cvt_pk_bf16_f32 v20, v20, v20
    v_cvt_pk_bf16_f32 v22, v22, v22
    v_add_f32_dpp v9, v9, v9 row_ror:8 row_mask:0xf bank_mask:0xf
    v_mov_b32 v3, v9
    s_nop 1
    v_permlane16_swap_b32 v9, v3
    v_add_f32 v9, v9, v3
    v_mov_b32 v3, v9
    s_nop 1
    v_permlane32_swap_b32 v9, v3
    v_add_f32 v9, v9, v3
    v_bfe_u32 v3, v0, 2, 1
    v_lshlrev_b32 v3, 3, v3
    s_lshl_b32 s9, s3, 4
    v_add_u32 v3, s9, v3
    ds_write_b64 v3, v[8:9] offset:1792
    v_mov_b32 v1, 1
    s_mov_b64 exec, 1
    ds_add_u32 v6, v1 offset:4
    s_mov_b64 exec, -1
    v_bfe_u32 v1, v0, 3, 1
    v_and_b32 v3, 3, v0
    v_lshl_add_u32 v1, v1, 2, v3
    v_mov_b32 v23, v5
    v_and_b32 v24, 1, v1
    v_lshlrev_b32 v24, 4, v24
    v_mov_b32 v25, 0xffff
    v_lshlrev_b32 v24, v24, v25
    v_lshrrev_b32 v25, 1, v1
    v_cmp_eq_u32 vcc, 0, v25
    s_nop 1
    v_cndmask_b32 v4, 0, v24, vcc
    v_cmp_eq_u32 vcc, 1, v25
    s_nop 1
    v_cndmask_b32 v5, 0, v24, vcc
    v_cmp_eq_u32 vcc, 2, v25
    s_nop 1
    v_cndmask_b32 v6, 0, v24, vcc
    v_cmp_eq_u32 vcc, 3, v25
    s_nop 1
    v_cndmask_b32 v7, 0, v24, vcc
    v_lshlrev_b32 v21, 4, v0
    s_lshl_b32 s9, s3, 11
    v_add_u32 v21, s9, v21
    s_waitcnt lgkmcnt(0)
    v_mov_b32_dpp v1, v32 row_ror:8 row_mask:0xf bank_mask:0xf
    v_cndmask_b32 v1, v32, v1, s[76:77]
    v_and_b32 v8, v1, v4
    v_and_b32 v9, v1, v5
    v_and_b32 v10, v1, v6
    v_and_b32 v11, v1, v7
    s_waitcnt vmcnt(3)
    buffer_load_dwordx4 v[68:71], v2, s[44:47], s49 offen offset:2304 nt
    v_mov_b32_dpp v1, v32 row_ror:8 row_mask:0xf bank_mask:0xf
    v_cndmask_b32 v1, v1, v32, s[76:77]
    v_and_b32 v12, v1, v4
    v_and_b32 v13, v1, v5
    v_and_b32 v14, v1, v6
    v_and_b32 v15, v1, v7
    v_mfma_f32_16x16x32_bf16 v[24:27], v[8:11], v[40:43], 0
    v_mfma_f32_16x16x32_bf16 v[28:31], v[8:11], v[44:47], 0
    v_mov_b32_dpp v1, v33 row_ror:8 row_mask:0xf bank_mask:0xf
    v_cndmask_b32 v1, v33, v1, s[76:77]
    v_and_b32 v16, v1, v4
    v_and_b32 v17, v1, v5
    v_and_b32 v18, v1, v6
    v_and_b32 v19, v1, v7
    v_mfma_f32_16x16x32_bf16 v[24:27], v[12:15], v[48:51], v[24:27]
    s_waitcnt vmcnt(3)
    buffer_load_dwordx4 v[72:75], v2, s[44:47], s50 offen offset:0 nt
    v_mfma_f32_16x16x32_bf16 v[28:31], v[12:15], v[52:55], v[28:31]
    v_mov_b32_dpp v1, v33 row_ror:8 row_mask:0xf bank_mask:0xf
    v_cndmask_b32 v1, v1, v33, s[76:77]
    v_and_b32 v8, v1, v4
    v_and_b32 v9, v1, v5
    v_and_b32 v10, v1, v6
    v_and_b32 v11, v1, v7
    v_mfma_f32_16x16x32_bf16 v[24:27], v[16:19], v[56:59], v[24:27]
    s_waitcnt vmcnt(3)
    buffer_load_dwordx4 v[76:79], v2, s[44:47], s50 offen offset:256 nt
    v_mfma_f32_16x16x32_bf16 v[28:31], v[16:19], v[60:63], v[28:31]
    s_waitcnt vmcnt(3)
    buffer_load_dwordx4 v[80:83], v2, s[44:47], s50 offen offset:2048 nt
    v_mov_b32_dpp v1, v34 row_ror:8 row_mask:0xf bank_mask:0xf
    v_cndmask_b32 v1, v34, v1, s[76:77]
    v_and_b32 v12, v1, v4
    v_and_b32 v13, v1, v5
    v_and_b32 v14, v1, v6
    v_and_b32 v15, v1, v7
    v_mfma_f32_16x16x32_bf16 v[24:27], v[8:11], v[64:67], v[24:27]
    s_waitcnt vmcnt(3)
    buffer_load_dwordx4 v[84:87], v2, s[44:47], s50 offen offset:2304 nt
    v_mfma_f32_16x16x32_bf16 v[28:31], v[8:11], v[68:71], v[28:31]
    s_waitcnt vmcnt(3)
    buffer_load_dwordx4 v[88:91], v2, s[44:47], s51 offen offset:0 nt
    v_mov_b32_dpp v1, v34 row_ror:8 row_mask:0xf bank_mask:0xf
    v_cndmask_b32 v1, v1, v34, s[76:77]
    v_and_b32 v16, v1, v4
    v_and_b32 v17, v1, v5
    v_and_b32 v18, v1, v6
    v_and_b32 v19, v1, v7
    v_mfma_f32_16x16x32_bf16 v[24:27], v[12:15], v[72:75], v[24:27]
    s_waitcnt vmcnt(3)
    buffer_load_dwordx4 v[92:95], v2, s[44:47], s51 offen offset:256 nt
    v_mfma_f32_16x16x32_bf16 v[28:31], v[12:15], v[76:79], v[28:31]
    s_waitcnt vmcnt(3)
    buffer_load_dwordx4 v[96:99], v2, s[44:47], s51 offen offset:2048 nt
    v_mov_b32_dpp v1, v35 row_ror:8 row_mask:0xf bank_mask:0xf
    v_cndmask_b32 v1, v35, v1, s[76:77]
    v_and_b32 v8, v1, v4
    v_and_b32 v9, v1, v5
    v_and_b32 v10, v1, v6
    v_and_b32 v11, v1, v7
    v_mfma_f32_16x16x32_bf16 v[24:27], v[16:19], v[80:83], v[24:27]
    s_waitcnt vmcnt(3)
    buffer_load_dwordx4 v[100:103], v2, s[44:47], s51 offen offset:2304 nt
    v_mfma_f32_16x16x32_bf16 v[28:31], v[16:19], v[84:87], v[28:31]
    s_waitcnt vmcnt(3)
    buffer_load_dwordx4 v[104:107], v2, s[44:47], s52 offen offset:0 nt
    v_mov_b32_dpp v1, v35 row_ror:8 row_mask:0xf bank_mask:0xf
    v_cndmask_b32 v1, v1, v35, s[76:77]
    v_and_b32 v12, v1, v4
    v_and_b32 v13, v1, v5
    v_and_b32 v14, v1, v6
    v_and_b32 v15, v1, v7
    v_mfma_f32_16x16x32_bf16 v[24:27], v[8:11], v[88:91], v[24:27]
    s_waitcnt vmcnt(3)
    buffer_load_dwordx4 v[108:111], v2, s[44:47], s52 offen offset:256 nt
    v_mfma_f32_16x16x32_bf16 v[28:31], v[8:11], v[92:95], v[28:31]
    s_waitcnt vmcnt(3)
    buffer_load_dwordx4 v[112:115], v2, s[44:47], s52 offen offset:2048 nt
    v_mov_b32_dpp v1, v36 row_ror:8 row_mask:0xf bank_mask:0xf
    v_cndmask_b32 v1, v36, v1, s[76:77]
    v_and_b32 v16, v1, v4
    v_and_b32 v17, v1, v5
    v_and_b32 v18, v1, v6
    v_and_b32 v19, v1, v7
    v_mfma_f32_16x16x32_bf16 v[24:27], v[12:15], v[96:99], v[24:27]
    s_waitcnt vmcnt(3)
    buffer_load_dwordx4 v[116:119], v2, s[44:47], s52 offen offset:2304 nt
    v_mfma_f32_16x16x32_bf16 v[28:31], v[12:15], v[100:103], v[28:31]
    s_waitcnt vmcnt(3)
    buffer_load_dwordx4 v[120:123], v2, s[44:47], s53 offen offset:0 nt
    v_mov_b32_dpp v1, v36 row_ror:8 row_mask:0xf bank_mask:0xf
    v_cndmask_b32 v1, v1, v36, s[76:77]
    v_and_b32 v8, v1, v4
    v_and_b32 v9, v1, v5
    v_and_b32 v10, v1, v6
    v_and_b32 v11, v1, v7
    v_mfma_f32_16x16x32_bf16 v[24:27], v[16:19], v[104:107], v[24:27]
    s_waitcnt vmcnt(3)
    buffer_load_dwordx4 v[124:127], v2, s[44:47], s53 offen offset:256 nt
    v_mfma_f32_16x16x32_bf16 v[28:31], v[16:19], v[108:111], v[28:31]
    s_waitcnt vmcnt(3)
    buffer_load_dwordx4 v[128:131], v2, s[44:47], s53 offen offset:2048 nt
    v_mov_b32_dpp v1, v37 row_ror:8 row_mask:0xf bank_mask:0xf
    v_cndmask_b32 v1, v37, v1, s[76:77]
    v_and_b32 v12, v1, v4
    v_and_b32 v13, v1, v5
    v_and_b32 v14, v1, v6
    v_and_b32 v15, v1, v7
    v_mfma_f32_16x16x32_bf16 v[24:27], v[8:11], v[112:115], v[24:27]
    s_waitcnt vmcnt(3)
    buffer_load_dwordx4 v[132:135], v2, s[44:47], s53 offen offset:2304 nt
    v_mfma_f32_16x16x32_bf16 v[28:31], v[8:11], v[116:119], v[28:31]
    s_waitcnt vmcnt(3)
    buffer_load_dwordx4 v[136:139], v2, s[44:47], s54 offen offset:0 nt
    v_mov_b32_dpp v1, v37 row_ror:8 row_mask:0xf bank_mask:0xf
    v_cndmask_b32 v1, v1, v37, s[76:77]
    v_and_b32 v16, v1, v4
    v_and_b32 v17, v1, v5
    v_and_b32 v18, v1, v6
    v_and_b32 v19, v1, v7
    v_mfma_f32_16x16x32_bf16 v[24:27], v[12:15], v[120:123], v[24:27]
    s_waitcnt vmcnt(3)
    buffer_load_dwordx4 v[140:143], v2, s[44:47], s54 offen offset:256 nt
    v_mfma_f32_16x16x32_bf16 v[28:31], v[12:15], v[124:127], v[28:31]
    s_waitcnt vmcnt(3)
    buffer_load_dwordx4 v[144:147], v2, s[44:47], s54 offen offset:2048 nt
    v_mov_b32_dpp v1, v38 row_ror:8 row_mask:0xf bank_mask:0xf
    v_cndmask_b32 v1, v38, v1, s[76:77]
    v_and_b32 v8, v1, v4
    v_and_b32 v9, v1, v5
    v_and_b32 v10, v1, v6
    v_and_b32 v11, v1, v7
    v_mfma_f32_16x16x32_bf16 v[24:27], v[16:19], v[128:131], v[24:27]
    s_waitcnt vmcnt(3)
    buffer_load_dwordx4 v[148:151], v2, s[44:47], s54 offen offset:2304 nt
    v_mfma_f32_16x16x32_bf16 v[28:31], v[16:19], v[132:135], v[28:31]
    s_waitcnt vmcnt(3)
    buffer_load_dwordx4 v[152:155], v2, s[44:47], s55 offen offset:0 nt
    v_mov_b32_dpp v1, v38 row_ror:8 row_mask:0xf bank_mask:0xf
    v_cndmask_b32 v1, v1, v38, s[76:77]
    v_and_b32 v12, v1, v4
    v_and_b32 v13, v1, v5
    v_and_b32 v14, v1, v6
    v_and_b32 v15, v1, v7
    v_mfma_f32_16x16x32_bf16 v[24:27], v[8:11], v[136:139], v[24:27]
    s_waitcnt vmcnt(3)
    buffer_load_dwordx4 v[156:159], v2, s[44:47], s55 offen offset:256 nt
    v_mfma_f32_16x16x32_bf16 v[28:31], v[8:11], v[140:143], v[28:31]
    s_waitcnt vmcnt(3)
    buffer_load_dwordx4 v[160:163], v2, s[44:47], s55 offen offset:2048 nt
    v_mov_b32_dpp v1, v39 row_ror:8 row_mask:0xf bank_mask:0xf
    v_cndmask_b32 v1, v39, v1, s[76:77]
    v_and_b32 v16, v1, v4
    v_and_b32 v17, v1, v5
    v_and_b32 v18, v1, v6
    v_and_b32 v19, v1, v7
    v_mfma_f32_16x16x32_bf16 v[24:27], v[12:15], v[144:147], v[24:27]
    s_waitcnt vmcnt(3)
    buffer_load_dwordx4 v[164:167], v2, s[44:47], s55 offen offset:2304 nt
    v_mfma_f32_16x16x32_bf16 v[28:31], v[12:15], v[148:151], v[28:31]
    s_waitcnt vmcnt(3)
    buffer_load_dwordx4 v[40:43], v2, s[44:47], s56 offen offset:0 nt
    v_mov_b32_dpp v1, v39 row_ror:8 row_mask:0xf bank_mask:0xf
    v_cndmask_b32 v1, v1, v39, s[76:77]
    v_and_b32 v8, v1, v4
    v_and_b32 v9, v1, v5
    v_and_b32 v10, v1, v6
    v_and_b32 v11, v1, v7
    v_mfma_f32_16x16x32_bf16 v[24:27], v[16:19], v[152:155], v[24:27]
    s_waitcnt vmcnt(3)
    buffer_load_dwordx4 v[44:47], v2, s[44:47], s56 offen offset:256 nt
    v_mfma_f32_16x16x32_bf16 v[28:31], v[16:19], v[156:159], v[28:31]
    s_waitcnt vmcnt(3)
    buffer_load_dwordx4 v[48:51], v2, s[44:47], s56 offen offset:2048 nt
    v_mov_b32_dpp v1, v20 row_ror:8 row_mask:0xf bank_mask:0xf
    v_cndmask_b32 v1, v20, v1, s[76:77]
    v_and_b32 v12, v1, v4
    v_and_b32 v13, v1, v5
    v_and_b32 v14, v1, v6
    v_and_b32 v15, v1, v7
    v_mfma_f32_16x16x32_bf16 v[24:27], v[8:11], v[160:163], v[24:27]
    buffer_load_dwordx4 v[52:55], v2, s[44:47], s56 offen offset:2304 nt
    buffer_load_dwordx4 v[56:59], v2, s[44:47], s57 offen offset:0 nt
    buffer_load_dwordx4 v[60:63], v2, s[44:47], s57 offen offset:256 nt
    buffer_load_dwordx4 v[64:67], v2, s[44:47], s57 offen offset:2048 nt
    buffer_load_dwordx4 v[68:71], v2, s[44:47], s57 offen offset:2304 nt
    s_waitcnt vmcnt(8)
    v_mfma_f32_16x16x32_bf16 v[28:31], v[8:11], v[164:167], v[28:31]
    s_waitcnt vmcnt(7)
    v_mov_b32_dpp v1, v20 row_ror:8 row_mask:0xf bank_mask:0xf
    v_cndmask_b32 v1, v1, v20, s[76:77]
    v_and_b32 v16, v1, v4
    v_and_b32 v17, v1, v5
    v_and_b32 v18, v1, v6
    v_and_b32 v19, v1, v7
    v_mfma_f32_16x16x32_bf16 v[24:27], v[12:15], v[40:43], v[24:27]
    s_waitcnt vmcnt(6)
    v_mfma_f32_16x16x32_bf16 v[28:31], v[12:15], v[44:47], v[28:31]
    s_waitcnt vmcnt(5)
    v_mov_b32_dpp v1, v22 row_ror:8 row_mask:0xf bank_mask:0xf
    v_cndmask_b32 v1, v22, v1, s[76:77]
    v_and_b32 v8, v1, v4
    v_and_b32 v9, v1, v5
    v_and_b32 v10, v1, v6
    v_and_b32 v11, v1, v7
    v_mfma_f32_16x16x32_bf16 v[24:27], v[16:19], v[48:51], v[24:27]
    s_waitcnt vmcnt(4)
    v_mfma_f32_16x16x32_bf16 v[28:31], v[16:19], v[52:55], v[28:31]
    s_waitcnt vmcnt(3)
    v_mov_b32_dpp v1, v22 row_ror:8 row_mask:0xf bank_mask:0xf
    v_cndmask_b32 v1, v1, v22, s[76:77]
    v_and_b32 v12, v1, v4
    v_and_b32 v13, v1, v5
    v_and_b32 v14, v1, v6
    v_and_b32 v15, v1, v7
    v_mfma_f32_16x16x32_bf16 v[24:27], v[8:11], v[56:59], v[24:27]
    s_waitcnt vmcnt(2)
    v_mfma_f32_16x16x32_bf16 v[28:31], v[8:11], v[60:63], v[28:31]
    s_waitcnt vmcnt(1)
    v_mfma_f32_16x16x32_bf16 v[24:27], v[12:15], v[64:67], v[24:27]
    s_waitcnt vmcnt(0)
    v_mfma_f32_16x16x32_bf16 v[28:31], v[12:15], v[68:71], v[28:31]
    s_nop 7
L_sfin:
    ds_write_b128 v21, v[24:27] offset:8192
    ds_write_b128 v21, v[28:31] offset:9216
    s_waitcnt lgkmcnt(0)
    s_barrier
    s_endpgm
L_help:
    s_cmp_ge_u32 s3, 2
    s_cbranch_scc1 L_end
    s_waitcnt lgkmcnt(0)
    s_mov_b32 s60, s38
    s_and_b32 s61, s39, 0xffff
    s_mov_b32 s62, 0x800000
    s_mov_b32 s63, 0x00020000
    v_mov_b32 v2, 0
    buffer_load_dword v3, v2, s[60:63], 0 offen sc1
    s_mov_b32 s80, 0x0fffffff
    s_mov_b32 s81, 0x0fffffff
    s_mov_b32 s78, 0x3db8aa3b
    s_mov_b32 s86, 0x3ff
    s_mov_b32 s87, 0xffff
    s_mov_b32 s88, 0xfffffc00
    v_mov_b32 v24, 0
    v_mov_b32 v25, 0
    v_mov_b32 v26, 0
    v_mov_b32 v27, 0
    ds_write_b128 v2, v[24:27]
    ds_write_b128 v2, v[24:27] offset:16
    v_lshlrev_b32 v7, 3, v0
    ds_write_b64 v7, v[24:25] offset:1280
    s_waitcnt lgkmcnt(0)
    s_barrier
    s_waitcnt vmcnt(0)
    v_add_u32 v3, 1, v3
    v_and_b32 v4, s86, v3
    v_and_b32 v5, s87, v3
    s_cmp_lg_u32 s3, 0
    s_cbranch_scc1 L_h1
    v_lshlrev_b32 v36, 5, v0
    s_lshl_b32 s40, s8, 11
    s_add_u32 s40, s40, 0xe0000
    s_add_u32 s41, s40, 32768
    s_add_u32 s42, s40, 65536
    s_add_u32 s43, s40, 98304
    v_and_b32 v38, 0xff, v3
    s_mov_b32 s47, 0xff
    s_mov_b32 s83, 0x30d400
L_lw_5:
    ds_read_b32 v37, v2 offset:12
    s_waitcnt lgkmcnt(0)
    v_readfirstlane_b32 s46, v37
    s_nop 0
    s_cmp_ge_u32 s46, 1
    s_cbranch_scc1 L_lwd_6
    s_sleep 2
    s_sub_u32 s83, s83, 1
    s_cbranch_scc0 L_lw_5
L_lwd_6:
    s_mov_b32 s82, 0x61a80
L_poll_7:
    buffer_load_dwordx4 v[24:27], v36, s[60:63], s40 offen sc1
    buffer_load_dwordx4 v[28:31], v36, s[60:63], s40 offen offset:16 sc1
    s_waitcnt vmcnt(1)
    v_bitop3_b32 v73, v24, v25, v5 bitop3:0x7e
    v_bitop3_b32 v74, v26, v27, v5 bitop3:0x7e
    v_or_b32 v72, v73, v74
    s_waitcnt vmcnt(0)
    v_bitop3_b32 v73, v28, v29, v5 bitop3:0x7e
    v_bitop3_b32 v74, v30, v31, v5 bitop3:0x7e
    v_or3_b32 v72, v72, v73, v74
    v_and_b32 v72, s87, v72
    v_cmp_ne_u32 vcc, 0, v72
    s_cbranch_vccz L_done_8
    s_mov_b64 exec, vcc
    s_sleep 8
    s_sub_u32 s82, s82, 1
    s_cbranch_scc0 L_poll_7
L_done_8:
    s_mov_b64 exec, -1
    s_mov_b32 s46, 0x07060302
    v_perm_b32 v32, v25, v24, s46
    v_perm_b32 v33, v27, v26, s46
    v_perm_b32 v34, v29, v28, s46
    v_perm_b32 v35, v31, v30, s46
    v_lshlrev_b32 v36, 4, v0
    ds_write_b128 v36, v[32:35] offset:256
    v_mov_b32 v37, 1
    s_mov_b64 exec, 1
    ds_add_u32 v2, v37 offset:0
    s_mov_b64 exec, -1
L_h1:
    s_mov_b32 s10, 0x30d400
L_lw_9:
    ds_read_b32 v1, v2 offset:4
    s_waitcnt lgkmcnt(0)
    v_readfirstlane_b32 s9, v1
    s_nop 0
    s_cmp_ge_u32 s9, 8
    s_cbranch_scc1 L_lwd_10
    s_sleep 2
    s_sub_u32 s10, s10, 1
    s_cbranch_scc0 L_lw_9
L_lwd_10:
    v_bfe_u32 v6, v0, 4, 1
    v_lshlrev_b32 v6, 3, v6
    ds_read_b64 v[40:41], v6 offset:1792
    ds_read_b64 v[42:43], v6 offset:1808
    ds_read_b64 v[44:45], v6 offset:1824
    ds_read_b64 v[46:47], v6 offset:1840
    ds_read_b64 v[48:49], v6 offset:1856
    ds_read_b64 v[50:51], v6 offset:1872
    ds_read_b64 v[52:53], v6 offset:1888
    ds_read_b64 v[54:55], v6 offset:1904
    s_waitcnt lgkmcnt(0)
    v_max3_f32 v32, v40, v42, v44
    v_max3_f32 v32, v32, v46, v48
    v_max3_f32 v32, v32, v50, v52
    v_max_f32 v32, v32, v54
    v_mul_f32 v7, s78, v32
    v_fma_f32 v24, v40, s78, -v7
    v_fma_f32 v25, v42, s78, -v7
    v_fma_f32 v26, v44, s78, -v7
    v_fma_f32 v27, v46, s78, -v7
    v_fma_f32 v28, v48, s78, -v7
    v_fma_f32 v29, v50, s78, -v7
    v_fma_f32 v30, v52, s78, -v7
    v_fma_f32 v31, v54, s78, -v7
    v_exp_f32 v24, v24
    v_exp_f32 v25, v25
    v_exp_f32 v26, v26
    v_exp_f32 v27, v27
    v_exp_f32 v28, v28
    v_exp_f32 v29, v29
    v_exp_f32 v30, v30
    v_exp_f32 v31, v31
    s_lshl_b32 s10, s8, 4
    s_add_u32 s10, s10, s6
    s_cmp_lg_u32 s3, 0
    s_cbranch_scc1 L_nopub
    v_mul_f32 v33, v24, v41
    v_fmac_f32 v33, v25, v43
    v_fmac_f32 v33, v26, v45
    v_fmac_f32 v33, v27, v47
    v_fmac_f32 v33, v28, v49
    v_fmac_f32 v33, v29, v51
    v_fmac_f32 v33, v30, v53
    v_fmac_f32 v33, v31, v55
    v_and_or_b32 v32, v32, s88, v4
    v_and_or_b32 v33, v33, s88, v4
    v_mov_b32 v34, v32
    v_mov_b32 v35, v33
    v_lshlrev_b32 v6, 1, v6
    s_lshl_b32 s9, s10, 5
    s_add_u32 s9, s9, 0x14000
    s_mov_b64 exec, 0x10001
    buffer_store_dwordx4 v[32:35], v6, s[60:63], s9 offen sc1
    s_mov_b64 exec, -1
L_nopub:
    v_bfe_u32 v8, v0, 4, 1
    v_lshlrev_b32 v8, 10, v8
    v_and_b32 v7, 15, v0
    v_lshl_add_u32 v8, v7, 5, v8
    v_lshrrev_b32 v7, 5, v0
    v_lshl_add_u32 v8, v7, 4, v8
    s_lshl_b32 s10, s10, 11
    s_lshl_b32 s9, s3, 9
    s_add_u32 s10, s10, s9
    s_add_u32 s10, s10, 0x20000
    v_lshlrev_b32 v9, 4, v0
    s_lshl_b32 s9, s3, 10
    v_add_u32 v9, s9, v9
    s_barrier
    ds_read_b128 v[40:43], v9 offset:8192
    ds_read_b128 v[44:47], v9 offset:10240
    ds_read_b128 v[48:51], v9 offset:12288
    ds_read_b128 v[52:55], v9 offset:14336
    ds_read_b128 v[56:59], v9 offset:16384
    ds_read_b128 v[60:63], v9 offset:18432
    ds_read_b128 v[64:67], v9 offset:20480
    ds_read_b128 v[68:71], v9 offset:22528
    s_waitcnt lgkmcnt(7)
    v_pk_mul_f32 v[32:33], v[24:25], v[40:41] op_sel:[0,0] op_sel_hi:[0,1]
    v_pk_mul_f32 v[34:35], v[24:25], v[42:43] op_sel:[0,0] op_sel_hi:[0,1]
    s_waitcnt lgkmcnt(6)
    v_pk_fma_f32 v[32:33], v[24:25], v[44:45], v[32:33] op_sel:[1,0,0] op_sel_hi:[1,1,1]
    v_pk_fma_f32 v[34:35], v[24:25], v[46:47], v[34:35] op_sel:[1,0,0] op_sel_hi:[1,1,1]
    s_waitcnt lgkmcnt(5)
    v_pk_fma_f32 v[32:33], v[26:27], v[48:49], v[32:33] op_sel:[0,0,0] op_sel_hi:[0,1,1]
    v_pk_fma_f32 v[34:35], v[26:27], v[50:51], v[34:35] op_sel:[0,0,0] op_sel_hi:[0,1,1]
    s_waitcnt lgkmcnt(4)
    v_pk_fma_f32 v[32:33], v[26:27], v[52:53], v[32:33] op_sel:[1,0,0] op_sel_hi:[1,1,1]
    v_pk_fma_f32 v[34:35], v[26:27], v[54:55], v[34:35] op_sel:[1,0,0] op_sel_hi:[1,1,1]
    s_waitcnt lgkmcnt(3)
    v_pk_fma_f32 v[32:33], v[28:29], v[56:57], v[32:33] op_sel:[0,0,0] op_sel_hi:[0,1,1]
    v_pk_fma_f32 v[34:35], v[28:29], v[58:59], v[34:35] op_sel:[0,0,0] op_sel_hi:[0,1,1]
    s_waitcnt lgkmcnt(2)
    v_pk_fma_f32 v[32:33], v[28:29], v[60:61], v[32:33] op_sel:[1,0,0] op_sel_hi:[1,1,1]
    v_pk_fma_f32 v[34:35], v[28:29], v[62:63], v[34:35] op_sel:[1,0,0] op_sel_hi:[1,1,1]
    s_waitcnt lgkmcnt(1)
    v_pk_fma_f32 v[32:33], v[30:31], v[64:65], v[32:33] op_sel:[0,0,0] op_sel_hi:[0,1,1]
    v_pk_fma_f32 v[34:35], v[30:31], v[66:67], v[34:35] op_sel:[0,0,0] op_sel_hi:[0,1,1]
    s_waitcnt lgkmcnt(0)
    v_pk_fma_f32 v[32:33], v[30:31], v[68:69], v[32:33] op_sel:[1,0,0] op_sel_hi:[1,1,1]
    v_pk_fma_f32 v[34:35], v[30:31], v[70:71], v[34:35] op_sel:[1,0,0] op_sel_hi:[1,1,1]
    v_and_or_b32 v32, v32, s88, v4
    v_and_or_b32 v33, v33, s88, v4
    v_and_or_b32 v34, v34, s88, v4
    v_and_or_b32 v35, v35, s88, v4
    buffer_store_dwordx4 v[32:35], v8, s[60:63], s10 offen sc1
    s_endpgm
L_role:
    v_mov_b32 v8, 0
    v_mov_b32 v9, 0
    v_mov_b32 v23, 119568
    ds_write_b64 v23, v[8:9]
    ds_write_b64 v23, v[8:9] offset:8
    ds_write_b64 v23, v[8:9] offset:16
    ds_write_b64 v23, v[8:9] offset:24
    s_waitcnt lgkmcnt(0)
    s_mov_b32 s60, s38
    s_and_b32 s61, s39, 0xffff
    s_mov_b32 s62, 0x800000
    s_mov_b32 s63, 0x00020000
    v_mov_b32 v2, 0
    buffer_load_dword v3, v2, s[60:63], 0 offen sc1
    s_mov_b32 s80, 0x0fffffff
    s_mov_b32 s81, 0x0fffffff
    s_mov_b32 s78, 0x3db8aa3b
    s_mov_b32 s86, 0x3ff
    s_mov_b32 s87, 0xffff
    s_mov_b32 s88, 0xfffffc00
    s_barrier
    s_mov_b32 s56, s16
    s_and_b32 s57, s17, 0xffff
    s_mov_b32 s58, 0x700
    s_mov_b32 s59, 0x00020000
    s_mov_b32 s68, s34
    s_and_b32 s69, s35, 0xffff
    s_mov_b32 s70, 0x700
    s_mov_b32 s71, 0x00020000
    s_cmp_ge_u32 s3, 4
    s_cbranch_scc1 L_fw
    s_mov_b32 s64, s24
    s_and_b32 s65, s25, 0xffff
    s_mov_b32 s66, 0x380000
    s_mov_b32 s67, 0x00020000
    s_cmp_lg_u32 s3, 0
    s_cbranch_scc1 L_o1
    s_setprio 3
    v_lshrrev_b32 v6, 5, v0
    v_mul_u32_u24 v6, 896, v6
    v_and_b32 v7, 31, v0
    v_lshl_add_u32 v6, v7, 5, v6
    v_mov_b32 v7, 0x100000
    v_cndmask_b32 v7, v7, v6, s[80:81]
    buffer_load_dwordx4 v[56:59], v7, s[56:59], 0 offen
    buffer_load_dwordx4 v[60:63], v7, s[56:59], 0 offen offset:16
    v_add_u32 v6, 114688, v6
    s_waitcnt vmcnt(0)
    v_lshlrev_b32 v24, 16, v56
    v_and_b32 v25, 0xffff0000, v56
    v_lshlrev_b32 v26, 16, v57
    v_and_b32 v27, 0xffff0000, v57
    v_lshlrev_b32 v28, 16, v58
    v_and_b32 v29, 0xffff0000, v58
    v_lshlrev_b32 v30, 16, v59
    v_and_b32 v31, 0xffff0000, v59
    v_lshlrev_b32 v32, 16, v60
    v_and_b32 v33, 0xffff0000, v60
    v_lshlrev_b32 v34, 16, v61
    v_and_b32 v35, 0xffff0000, v61
    v_lshlrev_b32 v36, 16, v62
    v_and_b32 v37, 0xffff0000, v62
    v_lshlrev_b32 v38, 16, v63
    v_and_b32 v39, 0xffff0000, v63
    v_pk_add_f32 v[40:41], v[24:25], v[26:27]
    v_pk_add_f32 v[42:43], v[28:29], v[30:31]
    v_pk_add_f32 v[44:45], v[32:33], v[34:35]
    v_pk_add_f32 v[46:47], v[36:37], v[38:39]
    v_pk_add_f32 v[40:41], v[40:41], v[42:43]
    v_pk_add_f32 v[42:43], v[44:45], v[46:47]
    v_pk_add_f32 v[40:41], v[40:41], v[42:43]
    v_add_f32 v64, v40, v41
    s_nop 1
    v_add_f32_dpp v64, v64, v64 quad_perm:[1,0,3,2] row_mask:0xf bank_mask:0xf
    s_nop 1
    v_add_f32_dpp v64, v64, v64 quad_perm:[2,3,0,1] row_mask:0xf bank_mask:0xf
    s_nop 1
    v_add_f32_dpp v64, v64, v64 row_ror:8 row_mask:0xf bank_mask:0xf
    s_nop 1
    v_add_f32_dpp v64, v64, v64 row_ror:4 row_mask:0xf bank_mask:0xf
    v_mov_b32 v65, v64
    s_nop 1
    v_permlane16_swap_b32 v64, v65
    v_add_f32 v64, v64, v65
    v_mul_f32 v64, 0xbb124925, v64
    v_pk_add_f32 v[40:41], v[24:25], v[64:65] op_sel_hi:[1,0]
    v_pk_add_f32 v[42:43], v[26:27], v[64:65] op_sel_hi:[1,0]
    v_pk_add_f32 v[44:45], v[28:29], v[64:65] op_sel_hi:[1,0]
    v_pk_add_f32 v[46:47], v[30:31], v[64:65] op_sel_hi:[1,0]
    v_pk_add_f32 v[48:49], v[32:33], v[64:65] op_sel_hi:[1,0]
    v_pk_add_f32 v[50:51], v[34:35], v[64:65] op_sel_hi:[1,0]
    v_pk_add_f32 v[52:53], v[36:37], v[64:65] op_sel_hi:[1,0]
    v_pk_add_f32 v[54:55], v[38:39], v[64:65] op_sel_hi:[1,0]
    v_pk_mul_f32 v[66:67], v[40:41], v[40:41]
    v_pk_fma_f32 v[66:67], v[42:43], v[42:43], v[66:67]
    v_pk_fma_f32 v[66:67], v[44:45], v[44:45], v[66:67]
    v_pk_fma_f32 v[66:67], v[46:47], v[46:47], v[66:67]
    v_pk_fma_f32 v[66:67], v[48:49], v[48:49], v[66:67]
    v_pk_fma_f32 v[66:67], v[50:51], v[50:51], v[66:67]
    v_pk_fma_f32 v[66:67], v[52:53], v[52:53], v[66:67]
    v_pk_fma_f32 v[66:67], v[54:55], v[54:55], v[66:67]
    v_add_f32 v66, v66, v67
    v_cndmask_b32 v66, 0, v66, s[80:81]
    v_cvt_pk_bf16_f32 v64, v64, v64
    v_and_b32 v64, 0xffff0000, v64
    v_add_f32_dpp v66, v66, v66 quad_perm:[1,0,3,2] row_mask:0xf bank_mask:0xf
    v_mov_b32 v65, v64
    v_pk_add_f32 v[40:41], v[24:25], v[64:65]
    v_add_f32_dpp v66, v66, v66 quad_perm:[2,3,0,1] row_mask:0xf bank_mask:0xf
    v_pk_add_f32 v[42:43], v[26:27], v[64:65]
    v_pk_add_f32 v[44:45], v[28:29], v[64:65]
    v_add_f32_dpp v66, v66, v66 row_ror:8 row_mask:0xf bank_mask:0xf
    v_pk_add_f32 v[46:47], v[30:31], v[64:65]
    v_pk_add_f32 v[48:49], v[32:33], v[64:65]
    v_add_f32_dpp v66, v66, v66 row_ror:4 row_mask:0xf bank_mask:0xf
    v_mov_b32 v67, v66
    v_pk_add_f32 v[50:51], v[34:35], v[64:65]
    v_pk_add_f32 v[52:53], v[36:37], v[64:65]
    v_permlane16_swap_b32 v66, v67
    v_add_f32 v66, v66, v67
    v_mul_f32 v66, 0x3b124925, v66
    v_cvt_pk_bf16_f32 v66, v66, v66
    v_and_b32 v66, 0xffff0000, v66
    v_add_f32 v66, 0x3727c5ac, v66
    v_cvt_pk_bf16_f32 v66, v66, v66
    v_and_b32 v66, 0xffff0000, v66
    v_sqrt_f32 v66, v66
    v_pk_add_f32 v[54:55], v[38:39], v[64:65]
    v_cvt_pk_bf16_f32 v56, v40, v41
    v_cvt_pk_bf16_f32 v66, v66, v66
    v_and_b32 v66, 0xffff0000, v66
    v_rcp_f32 v66, v66
    v_cvt_pk_bf16_f32 v57, v42, v43
    v_cvt_pk_bf16_f32 v58, v44, v45
    v_cvt_pk_bf16_f32 v59, v46, v47
    v_cvt_pk_bf16_f32 v60, v48, v49
    v_cvt_pk_bf16_f32 v61, v50, v51
    v_cvt_pk_bf16_f32 v62, v52, v53
    v_cvt_pk_bf16_f32 v63, v54, v55
    v_lshlrev_b32 v40, 16, v56
    v_and_b32 v41, 0xffff0000, v56
    v_lshlrev_b32 v42, 16, v57
    v_and_b32 v43, 0xffff0000, v57
    v_lshlrev_b32 v44, 16, v58
    v_and_b32 v45, 0xffff0000, v58
    v_lshlrev_b32 v46, 16, v59
    v_and_b32 v47, 0xffff0000, v59
    v_lshlrev_b32 v48, 16, v60
    v_and_b32 v49, 0xffff0000, v60
    v_lshlrev_b32 v50, 16, v61
    v_and_b32 v51, 0xffff0000, v61
    v_lshlrev_b32 v52, 16, v62
    v_and_b32 v53, 0xffff0000, v62
    v_lshlrev_b32 v54, 16, v63
    v_and_b32 v55, 0xffff0000, v63
    v_pk_mul_f32 v[40:41], v[40:41], v[66:67] op_sel_hi:[1,0]
    v_pk_mul_f32 v[42:43], v[42:43], v[66:67] op_sel_hi:[1,0]
    v_pk_mul_f32 v[44:45], v[44:45], v[66:67] op_sel_hi:[1,0]
    v_pk_mul_f32 v[46:47], v[46:47], v[66:67] op_sel_hi:[1,0]
    v_pk_mul_f32 v[48:49], v[48:49], v[66:67] op_sel_hi:[1,0]
    v_pk_mul_f32 v[50:51], v[50:51], v[66:67] op_sel_hi:[1,0]
    v_pk_mul_f32 v[52:53], v[52:53], v[66:67] op_sel_hi:[1,0]
    v_pk_mul_f32 v[54:55], v[54:55], v[66:67] op_sel_hi:[1,0]
    v_cvt_pk_bf16_f32 v56, v40, v41
    v_cvt_pk_bf16_f32 v57, v42, v43
    v_cvt_pk_bf16_f32 v58, v44, v45
    v_cvt_pk_bf16_f32 v59, v46, v47
    v_cvt_pk_bf16_f32 v60, v48, v49
    v_cvt_pk_bf16_f32 v61, v50, v51
    v_cvt_pk_bf16_f32 v62, v52, v53
    v_cvt_pk_bf16_f32 v63, v54, v55
    s_mov_b64 exec, s[80:81]
    ds_write_b128 v6, v[56:59]
    ds_write_b128 v6, v[60:63] offset:16
    v_mov_b32 v7, 1
    s_mov_b64 exec, 1
    ds_add_u32 v23, v7 offset:0
    s_mov_b64 exec, -1
    s_setprio 0
L_o1:
    s_cmp_lg_u32 s3, 1
    s_cbranch_scc1 L_o2
    s_setprio 3
    s_getreg_b32 s9, hwreg(HW_REG_XCC_ID)
    s_and_b32 s9, s9, 0xff
    s_lshl_b32 s9, s9, 16
    s_lshl_b32 s10, s2, 2
    s_add_u32 s10, s10, 0x11000
    s_waitcnt vmcnt(0)
    v_add_u32 v6, 1, v3
    v_and_b32 v6, s87, v6
    v_or_b32 v6, s9, v6
    s_mov_b64 exec, 1
    buffer_store_dword v6, v2, s[60:63], s10 offen sc1
    s_mov_b64 exec, -1
    v_and_b32 v5, s87, v6
    v_lshlrev_b32 v8, 2, v0
    v_and_b32 v8, 0x7f, v8
    s_mov_b32 s9, 0x11000
    s_mov_b32 s82, 0x61a80
    s_mov_b32 s79, 0
L_xc_11:
    buffer_load_dword v9, v8, s[60:63], s9 offen sc1
    s_waitcnt vmcnt(0)
    v_and_b32 v10, s87, v9
    v_cmp_ne_u32 vcc, v10, v5
    s_cbranch_vccz L_xcd_12
    s_sleep 8
    s_sub_u32 s82, s82, 1
    s_cbranch_scc0 L_xc_11
L_xcd_12:
    v_readfirstlane_b32 s9, v9
    s_nop 1
    v_cmp_ne_u32 vcc, s9, v9
    s_nop 0
    s_cmp_eq_u64 vcc, 0
    s_cselect_b32 s79, 1, 0
    v_mov_b32 v8, s79
    v_mov_b32 v9, 119552
    ds_write_b32 v9, v8
    v_mov_b32 v12, -1
    v_mov_b32 v13, -1
    v_mov_b32 v14, -1
    v_mov_b32 v15, -1
    s_cmp_lt_u32 s2, 28
    s_cselect_b32 s9, -1, 0
    v_mov_b32 v16, s9
    v_mov_b32 v17, s9
    v_mov_b32 v18, s9
    v_mov_b32 v19, s9
    v_lshlrev_b32 v8, 4, v0
    s_mul_i32 s9, s2, 3584
    s_add_u32 s10, s9, 0xa0000
    s_add_u32 s11, s9, 0xc0000
    s_cmp_eq_u32 s79, 1
    s_cbranch_scc0 L_rp_13
    buffer_store_dwordx4 v[12:15], v8, s[60:63], s10 offen offset:0
L_re_14:
    s_cmp_eq_u32 s79, 1
    s_cbranch_scc0 L_rp_15
    buffer_store_dwordx4 v[16:19], v8, s[60:63], s11 offen offset:0
L_re_16:
    s_cmp_eq_u32 s79, 1
    s_cbranch_scc0 L_rp_17
    buffer_store_dwordx4 v[12:15], v8, s[60:63], s10 offen offset:1024
L_re_18:
    s_cmp_eq_u32 s79, 1
    s_cbranch_scc0 L_rp_19
    buffer_store_dwordx4 v[16:19], v8, s[60:63], s11 offen offset:1024
L_re_20:
    s_cmp_eq_u32 s79, 1
    s_cbranch_scc0 L_rp_21
    buffer_store_dwordx4 v[12:15], v8, s[60:63], s10 offen offset:2048
L_re_22:
    s_cmp_eq_u32 s79, 1
    s_cbranch_scc0 L_rp_23
    buffer_store_dwordx4 v[16:19], v8, s[60:63], s11 offen offset:2048
L_re_24:
    s_mov_b32 exec_hi, 0
    s_cmp_eq_u32 s79, 1
    s_cbranch_scc0 L_rp_25
    buffer_store_dwordx4 v[12:15], v8, s[60:63], s10 offen offset:3072
L_re_26:
    s_cmp_eq_u32 s79, 1
    s_cbranch_scc0 L_rp_27
    buffer_store_dwordx4 v[16:19], v8, s[60:63], s11 offen offset:3072
L_re_28:
    s_lshl_b32 s9, s2, 6
    s_add_u32 s9, s9, 0x12000
    s_cmp_lt_u32 s2, 28
    s_cselect_b32 s9, s9, 0x13000
    s_mov_b64 exec, 15
    s_cmp_eq_u32 s79, 1
    s_cbranch_scc0 L_rp_29
    buffer_store_dwordx4 v[12:15], v8, s[60:63], s9 offen
L_re_30:
    s_cmp_eq_u32 s79, 1
    s_cbranch_scc0 L_rp_31
    buffer_store_dwordx4 v[12:15], v8, s[60:63], s9 offen offset:1792
L_re_32:
    s_mov_b64 exec, -1
    s_waitcnt lgkmcnt(0)
L_o2:
    s_cmp_eq_u32 s3, 1
    s_cbranch_scc1 L_o2b
    s_waitcnt vmcnt(0)
L_o2b:
    v_add_u32 v3, 1, v3
    v_and_b32 v4, s86, v3
    v_and_b32 v5, s87, v3
    v_readfirstlane_b32 s13, v3
    v_lshrrev_b32 v1, 4, v0
    v_mul_u32_u24 v1, 7168, v1
    v_and_b32 v7, 15, v0
    v_lshl_add_u32 v1, v7, 4, v1
    s_mul_i32 s12, s2, 114688
    s_lshl_b32 s10, s3, 8
    s_add_u32 s12, s12, s10
    s_cmp_eq_u32 s3, 3
    s_cselect_b32 s15, 0x00ff00ff, -1
    s_mov_b32 s10, 0x30d400
L_lw_33:
    ds_read_b32 v7, v23 offset:8
    s_waitcnt lgkmcnt(0)
    v_readfirstlane_b32 s9, v7
    s_nop 0
    s_cmp_ge_u32 s9, 8
    s_cbranch_scc1 L_lwd_34
    s_sleep 2
    s_sub_u32 s10, s10, 1
    s_cbranch_scc0 L_lw_33
L_lwd_34:
    s_mov_b32 exec_lo, s15
    s_mov_b32 exec_hi, s15
    s_cmp_lg_u32 s3, 1
    s_cbranch_scc1 L_o4
    v_mov_b32 v16, v5
    v_mov_b32 v17, v5
    v_mov_b32 v18, v5
    v_mov_b32 v19, v5
    s_lshl_b32 s9, s2, 4
    s_add_u32 s9, s9, 0x11800
    s_waitcnt vmcnt(0)
    s_mov_b64 exec, 1
    buffer_store_dwordx4 v[16:19], v2, s[60:63], s9 offen sc1
    s_mov_b64 exec, -1
    s_setprio 0
L_o4:
    s_waitcnt vmcnt(3)
    buffer_load_dwordx4 v[40:43], v1, s[64:67], s12 offen offset:0 nt
    s_waitcnt vmcnt(3)
    buffer_load_dwordx4 v[44:47], v1, s[64:67], s12 offen offset:896 nt
    s_waitcnt vmcnt(3)
    buffer_load_dwordx4 v[48:51], v1, s[64:67], s12 offen offset:1792 nt
    s_waitcnt vmcnt(3)
    buffer_load_dwordx4 v[52:55], v1, s[64:67], s12 offen offset:2688 nt
    s_add_u32 s12, s12, 3584
    s_waitcnt vmcnt(3)
    buffer_load_dwordx4 v[56:59], v1, s[64:67], s12 offen offset:0 nt
    s_waitcnt vmcnt(3)
    buffer_load_dwordx4 v[60:63], v1, s[64:67], s12 offen offset:896 nt
    s_waitcnt vmcnt(3)
    buffer_load_dwordx4 v[64:67], v1, s[64:67], s12 offen offset:1792 nt
    s_waitcnt vmcnt(3)
    buffer_load_dwordx4 v[68:71], v1, s[64:67], s12 offen offset:2688 nt
    s_add_u32 s12, s12, 25088
    s_mov_b32 s10, 0x30d400
L_lw_35:
    ds_read_b32 v7, v23 offset:12
    s_waitcnt lgkmcnt(0)
    v_readfirstlane_b32 s9, v7
    s_nop 0
    s_cmp_ge_u32 s9, 1
    s_cbranch_scc1 L_lwd_36
    s_sleep 2
    s_sub_u32 s10, s10, 1
    s_cbranch_scc0 L_lw_35
L_lwd_36:
    s_waitcnt vmcnt(3)
    buffer_load_dwordx4 v[72:75], v1, s[64:67], s12 offen offset:0 nt
    s_waitcnt vmcnt(3)
    buffer_load_dwordx4 v[76:79], v1, s[64:67], s12 offen offset:896 nt
    s_waitcnt vmcnt(3)
    buffer_load_dwordx4 v[80:83], v1, s[64:67], s12 offen offset:1792 nt
    s_waitcnt vmcnt(3)
    buffer_load_dwordx4 v[84:87], v1, s[64:67], s12 offen offset:2688 nt
    s_add_u32 s12, s12, 3584
    s_waitcnt vmcnt(3)
    buffer_load_dwordx4 v[88:91], v1, s[64:67], s12 offen offset:0 nt
    s_waitcnt vmcnt(3)
    buffer_load_dwordx4 v[92:95], v1, s[64:67], s12 offen offset:896 nt
    s_waitcnt vmcnt(3)
    buffer_load_dwordx4 v[96:99], v1, s[64:67], s12 offen offset:1792 nt
    s_waitcnt vmcnt(3)
    buffer_load_dwordx4 v[100:103], v1, s[64:67], s12 offen offset:2688 nt
    s_add_u32 s12, s12, 25088
    s_waitcnt vmcnt(3)
    buffer_load_dwordx4 v[104:107], v1, s[64:67], s12 offen offset:0 nt
    s_waitcnt vmcnt(3)
    buffer_load_dwordx4 v[108:111], v1, s[64:67], s12 offen offset:896 nt
    s_waitcnt vmcnt(3)
    buffer_load_dwordx4 v[112:115], v1, s[64:67], s12 offen offset:1792 nt
    s_waitcnt vmcnt(3)
    buffer_load_dwordx4 v[116:119], v1, s[64:67], s12 offen offset:2688 nt
    s_add_u32 s12, s12, 3584
    s_waitcnt vmcnt(3)
    buffer_load_dwordx4 v[120:123], v1, s[64:67], s12 offen offset:0 nt
    s_waitcnt vmcnt(3)
    buffer_load_dwordx4 v[124:127], v1, s[64:67], s12 offen offset:896 nt
    s_waitcnt vmcnt(3)
    buffer_load_dwordx4 v[128:131], v1, s[64:67], s12 offen offset:1792 nt
    s_waitcnt vmcnt(3)
    buffer_load_dwordx4 v[132:135], v1, s[64:67], s12 offen offset:2688 nt
    s_add_u32 s12, s12, 25088
    s_waitcnt vmcnt(3)
    buffer_load_dwordx4 v[136:139], v1, s[64:67], s12 offen offset:0 nt
    s_waitcnt vmcnt(3)
    buffer_load_dwordx4 v[140:143], v1, s[64:67], s12 offen offset:896 nt
    s_waitcnt vmcnt(3)
    buffer_load_dwordx4 v[144:147], v1, s[64:67], s12 offen offset:1792 nt
    s_waitcnt vmcnt(3)
    buffer_load_dwordx4 v[148:151], v1, s[64:67], s12 offen offset:2688 nt
    s_add_u32 s12, s12, 3584
    s_waitcnt vmcnt(3)
    buffer_load_dwordx4 v[152:155], v1, s[64:67], s12 offen offset:0 nt
    s_waitcnt vmcnt(3)
    buffer_load_dwordx4 v[156:159], v1, s[64:67], s12 offen offset:896 nt
    s_waitcnt vmcnt(3)
    buffer_load_dwordx4 v[160:163], v1, s[64:67], s12 offen offset:1792 nt
    s_waitcnt vmcnt(3)
    buffer_load_dwordx4 v[164:167], v1, s[64:67], s12 offen offset:2688 nt
    s_add_u32 s12, s12, 25088
    s_mov_b64 exec, -1
    s_cmp_lg_u32 s3, 1
    s_cbranch_scc1 L_o5
    v_and_b32 v8, 31, v0
    v_lshlrev_b32 v8, 4, v8
    s_mov_b32 s9, 0x11800
    s_mov_b32 s82, 0x61a80
L_poll_37:
    buffer_load_dwordx4 v[12:15], v8, s[60:63], s9 offen sc1
    s_waitcnt vmcnt(0)
    v_bitop3_b32 v10, v12, v13, v5 bitop3:0x7e
    v_bitop3_b32 v11, v14, v15, v5 bitop3:0x7e
    v_or_b32 v9, v10, v11
    v_and_b32 v9, s87, v9
    v_cmp_ne_u32 vcc, 0, v9
    s_cbranch_vccz L_done_38
    s_mov_b64 exec, vcc
    s_sleep 8
    s_sub_u32 s82, s82, 1
    s_cbranch_scc0 L_poll_37
L_done_38:
    s_mov_b64 exec, -1
    s_setprio 0
L_o5:
    s_mov_b32 s46, 0x05040100
    s_mov_b32 s47, 0x07060302
    s_waitcnt vmcnt(24)
    v_perm_b32 v8, v44, v40, s46
    v_perm_b32 v9, v52, v48, s46
    v_perm_b32 v10, v60, v56, s46
    v_perm_b32 v11, v68, v64, s46
    v_perm_b32 v12, v44, v40, s47
    v_perm_b32 v13, v52, v48, s47
    v_perm_b32 v14, v60, v56, s47
    v_perm_b32 v15, v68, v64, s47
    v_perm_b32 v16, v45, v41, s46
    v_perm_b32 v17, v53, v49, s46
    v_perm_b32 v18, v61, v57, s46
    v_perm_b32 v19, v69, v65, s46
    v_perm_b32 v20, v45, v41, s47
    v_perm_b32 v21, v53, v49, s47
    v_perm_b32 v22, v61, v57, s47
    v_perm_b32 v23, v69, v65, s47
    v_perm_b32 v24, v46, v42, s46
    v_perm_b32 v25, v54, v50, s46
    v_perm_b32 v26, v62, v58, s46
    v_perm_b32 v27, v70, v66, s46
    v_perm_b32 v28, v46, v42, s47
    v_perm_b32 v29, v54, v50, s47
    v_perm_b32 v30, v62, v58, s47
    v_perm_b32 v31, v70, v66, s47
    v_perm_b32 v32, v47, v43, s46
    v_perm_b32 v33, v55, v51, s46
    v_perm_b32 v34, v63, v59, s46
    v_perm_b32 v35, v71, v67, s46
    v_perm_b32 v36, v47, v43, s47
    v_perm_b32 v37, v55, v51, s47
    v_perm_b32 v38, v63, v59, s47
    v_perm_b32 v39, v71, v67, s47
    s_waitcnt vmcnt(16)
    v_perm_b32 v40, v76, v72, s46
    v_perm_b32 v41, v84, v80, s46
    v_perm_b32 v42, v92, v88, s46
    v_perm_b32 v43, v100, v96, s46
    v_perm_b32 v44, v76, v72, s47
    v_perm_b32 v45, v84, v80, s47
    v_perm_b32 v46, v92, v88, s47
    v_perm_b32 v47, v100, v96, s47
    v_perm_b32 v48, v77, v73, s46
    v_perm_b32 v49, v85, v81, s46
    v_perm_b32 v50, v93, v89, s46
    v_perm_b32 v51, v101, v97, s46
    v_perm_b32 v52, v77, v73, s47
    v_perm_b32 v53, v85, v81, s47
    v_perm_b32 v54, v93, v89, s47
    v_perm_b32 v55, v101, v97, s47
    v_perm_b32 v56, v78, v74, s46
    v_perm_b32 v57, v86, v82, s46
    v_perm_b32 v58, v94, v90, s46
    v_perm_b32 v59, v102, v98, s46
    v_perm_b32 v60, v78, v74, s47
    v_perm_b32 v61, v86, v82, s47
    v_perm_b32 v62, v94, v90, s47
    v_perm_b32 v63, v102, v98, s47
    v_perm_b32 v64, v79, v75, s46
    v_perm_b32 v65, v87, v83, s46
    v_perm_b32 v66, v95, v91, s46
    v_perm_b32 v67, v103, v99, s46
    v_perm_b32 v68, v79, v75, s47
    v_perm_b32 v69, v87, v83, s47
    v_perm_b32 v70, v95, v91, s47
    v_perm_b32 v71, v103, v99, s47
    s_waitcnt vmcnt(8)
    v_perm_b32 v72, v108, v104, s46
    v_perm_b32 v73, v116, v112, s46
    v_perm_b32 v74, v124, v120, s46
    v_perm_b32 v75, v132, v128, s46
    v_perm_b32 v76, v108, v104, s47
    v_perm_b32 v77, v116, v112, s47
    v_perm_b32 v78, v124, v120, s47
    v_perm_b32 v79, v132, v128, s47
    v_perm_b32 v80, v109, v105, s46
    v_perm_b32 v81, v117, v113, s46
    v_perm_b32 v82, v125, v121, s46
    v_perm_b32 v83, v133, v129, s46
    v_perm_b32 v84, v109, v105, s47
    v_perm_b32 v85, v117, v113, s47
    v_perm_b32 v86, v125, v121, s47
    v_perm_b32 v87, v133, v129, s47
    v_perm_b32 v88, v110, v106, s46
    v_perm_b32 v89, v118, v114, s46
    v_perm_b32 v90, v126, v122, s46
    v_perm_b32 v91, v134, v130, s46
    v_perm_b32 v92, v110, v106, s47
    v_perm_b32 v93, v118, v114, s47
    v_perm_b32 v94, v126, v122, s47
    v_perm_b32 v95, v134, v130, s47
    v_perm_b32 v96, v111, v107, s46
    v_perm_b32 v97, v119, v115, s46
    v_perm_b32 v98, v127, v123, s46
    v_perm_b32 v99, v135, v131, s46
    v_perm_b32 v100, v111, v107, s47
    v_perm_b32 v101, v119, v115, s47
    v_perm_b32 v102, v127, v123, s47
    v_perm_b32 v103, v135, v131, s47
    s_waitcnt vmcnt(0)
    v_perm_b32 v104, v140, v136, s46
    v_perm_b32 v105, v148, v144, s46
    v_perm_b32 v106, v156, v152, s46
    v_perm_b32 v107, v164, v160, s46
    v_perm_b32 v108, v140, v136, s47
    v_perm_b32 v109, v148, v144, s47
    v_perm_b32 v110, v156, v152, s47
    v_perm_b32 v111, v164, v160, s47
    v_perm_b32 v112, v141, v137, s46
    v_perm_b32 v113, v149, v145, s46
    v_perm_b32 v114, v157, v153, s46
    v_perm_b32 v115, v165, v161, s46
    v_perm_b32 v116, v141, v137, s47
    v_perm_b32 v117, v149, v145, s47
    v_perm_b32 v118, v157, v153, s47
    v_perm_b32 v119, v165, v161, s47
    v_perm_b32 v120, v142, v138, s46
    v_perm_b32 v121, v150, v146, s46
    v_perm_b32 v122, v158, v154, s46
    v_perm_b32 v123, v166, v162, s46
    v_perm_b32 v124, v142, v138, s47
    v_perm_b32 v125, v150, v146, s47
    v_perm_b32 v126, v158, v154, s47
    v_perm_b32 v127, v166, v162, s47
    v_perm_b32 v128, v143, v139, s46
    v_perm_b32 v129, v151, v147, s46
    v_perm_b32 v130, v159, v155, s46
    v_perm_b32 v131, v167, v163, s46
    v_perm_b32 v132, v143, v139, s47
    v_perm_b32 v133, v151, v147, s47
    v_perm_b32 v134, v159, v155, s47
    v_perm_b32 v135, v167, v163, s47
    v_mov_b32 v136, v12
    v_mov_b32 v137, v13
    v_mov_b32 v138, v14
    v_mov_b32 v139, v15
    v_mov_b32 v12, v40
    v_mov_b32 v13, v41
    v_mov_b32 v14, v42
    v_mov_b32 v15, v43
    v_mov_b32 v40, v24
    v_mov_b32 v41, v25
    v_mov_b32 v42, v26
    v_mov_b32 v43, v27
    v_mov_b32 v24, v16
    v_mov_b32 v25, v17
    v_mov_b32 v26, v18
    v_mov_b32 v27, v19
    v_mov_b32 v16, v136
    v_mov_b32 v17, v137
    v_mov_b32 v18, v138
    v_mov_b32 v19, v139
    v_mov_b32 v136, v20
    v_mov_b32 v137, v21
    v_mov_b32 v138, v22
    v_mov_b32 v139, v23
    v_mov_b32 v20, v44
    v_mov_b32 v21, v45
    v_mov_b32 v22, v46
    v_mov_b32 v23, v47
    v_mov_b32 v44, v56
    v_mov_b32 v45, v57
    v_mov_b32 v46, v58
    v_mov_b32 v47, v59
    v_mov_b32 v56, v32
    v_mov_b32 v57, v33
    v_mov_b32 v58, v34
    v_mov_b32 v59, v35
    v_mov_b32 v32, v136
    v_mov_b32 v33, v137
    v_mov_b32 v34, v138
    v_mov_b32 v35, v139
    v_mov_b32 v136, v28
    v_mov_b32 v137, v29
    v_mov_b32 v138, v30
    v_mov_b32 v139, v31
    v_mov_b32 v28, v48
    v_mov_b32 v29, v49
    v_mov_b32 v30, v50
    v_mov_b32 v31, v51
    v_mov_b32 v48, v136
    v_mov_b32 v49, v137
    v_mov_b32 v50, v138
    v_mov_b32 v51, v139
    v_mov_b32 v136, v36
    v_mov_b32 v137, v37
    v_mov_b32 v138, v38
    v_mov_b32 v139, v39
    v_mov_b32 v36, v52
    v_mov_b32 v37, v53
    v_mov_b32 v38, v54
    v_mov_b32 v39, v55
    v_mov_b32 v52, v60
    v_mov_b32 v53, v61
    v_mov_b32 v54, v62
    v_mov_b32 v55, v63
    v_mov_b32 v60, v64
    v_mov_b32 v61, v65
    v_mov_b32 v62, v66
    v_mov_b32 v63, v67
    v_mov_b32 v64, v136
    v_mov_b32 v65, v137
    v_mov_b32 v66, v138
    v_mov_b32 v67, v139
    v_mov_b32 v136, v76
    v_mov_b32 v137, v77
    v_mov_b32 v138, v78
    v_mov_b32 v139, v79
    v_mov_b32 v76, v104
    v_mov_b32 v77, v105
    v_mov_b32 v78, v106
    v_mov_b32 v79, v107
    v_mov_b32 v104, v88
    v_mov_b32 v105, v89
    v_mov_b32 v106, v90
    v_mov_b32 v107, v91
    v_mov_b32 v88, v80
    v_mov_b32 v89, v81
    v_mov_b32 v90, v82
    v_mov_b32 v91, v83
    v_mov_b32 v80, v136
    v_mov_b32 v81, v137
    v_mov_b32 v82, v138
    v_mov_b32 v83, v139
    v_mov_b32 v136, v84
    v_mov_b32 v137, v85
    v_mov_b32 v138, v86
    v_mov_b32 v139, v87
    v_mov_b32 v84, v108
    v_mov_b32 v85, v109
    v_mov_b32 v86, v110
    v_mov_b32 v87, v111
    v_mov_b32 v108, v120
    v_mov_b32 v109, v121
    v_mov_b32 v110, v122
    v_mov_b32 v111, v123
    v_mov_b32 v120, v96
    v_mov_b32 v121, v97
    v_mov_b32 v122, v98
    v_mov_b32 v123, v99
    v_mov_b32 v96, v136
    v_mov_b32 v97, v137
    v_mov_b32 v98, v138
    v_mov_b32 v99, v139
    v_mov_b32 v136, v92
    v_mov_b32 v137, v93
    v_mov_b32 v138, v94
    v_mov_b32 v139, v95
    v_mov_b32 v92, v112
    v_mov_b32 v93, v113
    v_mov_b32 v94, v114
    v_mov_b32 v95, v115
    v_mov_b32 v112, v136
    v_mov_b32 v113, v137
    v_mov_b32 v114, v138
    v_mov_b32 v115, v139
    v_mov_b32 v136, v100
    v_mov_b32 v137, v101
    v_mov_b32 v138, v102
    v_mov_b32 v139, v103
    v_mov_b32 v100, v116
    v_mov_b32 v101, v117
    v_mov_b32 v102, v118
    v_mov_b32 v103, v119
    v_mov_b32 v116, v124
    v_mov_b32 v117, v125
    v_mov_b32 v118, v126
    v_mov_b32 v119, v127
    v_mov_b32 v124, v128
    v_mov_b32 v125, v129
    v_mov_b32 v126, v130
    v_mov_b32 v127, v131
    v_mov_b32 v128, v136
    v_mov_b32 v129, v137
    v_mov_b32 v130, v138
    v_mov_b32 v131, v139
    s_mul_i32 s42, s2, 3584
    s_lshl_b32 s9, s3, 10
    s_add_u32 s42, s42, s9
    s_add_u32 s42, s42, 0xa0000
    s_cmp_eq_u32 s3, 3
    s_cselect_b32 s15, 0x00ff00ff, -1
    s_barrier
    v_mov_b32 v136, 119552
    ds_read_b32 v136, v136
    s_waitcnt lgkmcnt(0)
    v_readfirstlane_b32 s79, v136
    v_and_b32 v2, 15, v0
    v_lshlrev_b32 v2, 6, v2
    v_lshrrev_b32 v1, 4, v0
    v_lshl_add_u32 v2, v1, 4, v2
    v_lshrrev_b32 v1, 3, v0
    v_cmp_gt_u32 s[44:45], 48, v0
    s_lshr_b32 s4, s2, 2
    v_lshlrev_b32 v5, 11, v1
    v_and_b32 v7, 7, v0
    v_lshl_add_u32 v5, v7, 4, v5
    v_add_u32 v6, 16384, v5
    v_cndmask_b32 v6, v5, v6, s[44:45]
    s_lshl_b32 s40, s4, 15
    s_and_b32 s9, s2, 3
    s_lshl_b32 s9, s9, 2
    s_add_u32 s9, s9, s3
    s_lshl_b32 s9, s9, 7
    s_add_u32 s40, s40, s9
    s_add_u32 s40, s40, 0x20000
    s_add_u32 s41, s40, 0x40000
    s_lshl_b32 s9, s3, 5
    s_add_u32 s9, s9, 118784
    v_lshrrev_b32 v136, 4, v0
    v_lshlrev_b32 v3, 7, v136
    v_lshl_add_u32 v3, v7, 2, v3
    v_add_u32 v3, s9, v3
    v_and_b32 v7, 1, v0
    v_lshlrev_b32 v7, 8, v7
    v_lshl_add_u32 v7, v136, 4, v7
    v_bfe_u32 v136, v0, 1, 1
    v_lshl_add_u32 v7, v136, 7, v7
    v_add_u32 v7, 118784, v7
    v_mov_b32 v160, 0
    v_mov_b32 v161, 0
    s_lshl_b32 s43, s4, 9
    s_bfe_u32 s10, s2, 0x10001
    s_lshl_b32 s10, s10, 4
    s_add_u32 s43, s43, s10
    s_add_u32 s43, s43, 0x14000
    s_add_u32 s14, s43, 4096
    v_lshrrev_b32 v1, 3, v0
    v_lshlrev_b32 v160, 5, v1
    v_add_u32 v161, 256, v160
    v_cndmask_b32 v161, v160, v161, s[44:45]
    s_mov_b32 s82, 0x61a80
L_poll_39:
    buffer_load_dwordx4 v[136:139], v160, s[60:63], s43 offen sc1
    buffer_load_dwordx4 v[140:143], v161, s[60:63], s43 offen sc1
    buffer_load_dwordx4 v[144:147], v160, s[60:63], s14 offen sc1
    buffer_load_dwordx4 v[148:151], v161, s[60:63], s14 offen sc1
    s_waitcnt vmcnt(3)
    v_bitop3_b32 v157, v136, v137, v4 bitop3:0x7e
    v_bitop3_b32 v158, v138, v139, v4 bitop3:0x7e
    v_or_b32 v156, v157, v158
    s_waitcnt vmcnt(2)
    v_bitop3_b32 v157, v140, v141, v4 bitop3:0x7e
    v_bitop3_b32 v158, v142, v143, v4 bitop3:0x7e
    v_or3_b32 v156, v156, v157, v158
    s_waitcnt vmcnt(1)
    v_bitop3_b32 v157, v144, v145, v4 bitop3:0x7e
    v_bitop3_b32 v158, v146, v147, v4 bitop3:0x7e
    v_or3_b32 v156, v156, v157, v158
    s_waitcnt vmcnt(0)
    v_bitop3_b32 v157, v148, v149, v4 bitop3:0x7e
    v_bitop3_b32 v158, v150, v151, v4 bitop3:0x7e
    v_or3_b32 v156, v156, v157, v158
    v_and_b32 v156, s86, v156
    v_cmp_ne_u32 vcc, 0, v156
    s_cbranch_vccz L_done_40
    s_mov_b64 exec, vcc
    s_sleep 16
    s_sub_u32 s82, s82, 1
    s_cbranch_scc0 L_poll_39
L_done_40:
    s_mov_b64 exec, -1
    v_and_b32 v136, s88, v136
    v_and_b32 v137, s88, v137
    v_and_b32 v138, s88, v138
    v_and_b32 v139, s88, v139
    v_and_b32 v140, s88, v140
    v_and_b32 v141, s88, v141
    v_and_b32 v142, s88, v142
    v_and_b32 v143, s88, v143
    v_and_b32 v144, s88, v144
    v_and_b32 v145, s88, v145
    v_and_b32 v146, s88, v146
    v_and_b32 v147, s88, v147
    v_and_b32 v148, s88, v148
    v_and_b32 v149, s88, v149
    v_and_b32 v150, s88, v150
    v_and_b32 v151, s88, v151
    v_and_b32 v136, 0xffff0000, v136
    v_and_b32 v140, 0xffff0000, v140
    v_max_f32 v138, v136, v140
    s_nop 1
    v_max_f32_dpp v138, v138, v138 row_ror:8 row_mask:0xf bank_mask:0xf
    v_mov_b32 v139, v138
    s_nop 1
    v_permlane16_swap_b32 v138, v139
    v_max_f32 v138, v138, v139
    v_mov_b32 v139, v138
    s_nop 1
    v_permlane32_swap_b32 v138, v139
    v_max_f32 v138, v138, v139
    v_mul_f32 v138, s78, v138
    v_fma_f32 v136, v136, s78, -v138
    v_fma_f32 v140, v140, s78, -v138
    v_exp_f32 v136, v136
    v_exp_f32 v140, v140
    s_nop 0
    v_cndmask_b32 v140, 0, v140, s[44:45]
    v_mul_f32 v138, v136, v137
    v_fmac_f32 v138, v140, v141
    s_nop 1
    v_add_f32_dpp v138, v138, v138 row_ror:8 row_mask:0xf bank_mask:0xf
    v_mov_b32 v139, v138
    s_nop 1
    v_permlane16_swap_b32 v138, v139
    v_add_f32 v138, v138, v139
    v_mov_b32 v139, v138
    s_nop 1
    v_permlane32_swap_b32 v138, v139
    v_add_f32 v138, v138, v139
    v_rcp_f32 v138, v138
    s_nop 0
    v_mul_f32 v152, v136, v138
    v_mul_f32 v153, v140, v138
    v_and_b32 v144, 0xffff0000, v144
    v_and_b32 v148, 0xffff0000, v148
    v_max_f32 v138, v144, v148
    s_nop 1
    v_max_f32_dpp v138, v138, v138 row_ror:8 row_mask:0xf bank_mask:0xf
    v_mov_b32 v139, v138
    s_nop 1
    v_permlane16_swap_b32 v138, v139
    v_max_f32 v138, v138, v139
    v_mov_b32 v139, v138
    s_nop 1
    v_permlane32_swap_b32 v138, v139
    v_max_f32 v138, v138, v139
    v_mul_f32 v138, s78, v138
    v_fma_f32 v144, v144, s78, -v138
    v_fma_f32 v148, v148, s78, -v138
    v_exp_f32 v144, v144
    v_exp_f32 v148, v148
    s_nop 0
    v_cndmask_b32 v148, 0, v148, s[44:45]
    v_mul_f32 v138, v144, v145
    v_fmac_f32 v138, v148, v149
    s_nop 1
    v_add_f32_dpp v138, v138, v138 row_ror:8 row_mask:0xf bank_mask:0xf
    v_mov_b32 v139, v138
    s_nop 1
    v_permlane16_swap_b32 v138, v139
    v_add_f32 v138, v138, v139
    v_mov_b32 v139, v138
    s_nop 1
    v_permlane32_swap_b32 v138, v139
    v_add_f32 v138, v138, v139
    v_rcp_f32 v138, v138
    s_nop 0
    v_mul_f32 v154, v144, v138
    v_mul_f32 v155, v148, v138
    v_bfe_u32 v1, v0, 1, 1
    v_mul_u32_u24 v1, 0xaaaa, v1
    v_add_u32 v1, 0x4444, v1
    v_mov_b32 v160, 0
    v_mov_b32 v161, 0
    v_mov_b32 v162, 0
    v_mov_b32 v163, 0
    s_mov_b32 s82, 0x61a80
    s_mov_b64 s[84:85], exec
    s_mov_b32 exec_lo, 0x1010101
    s_mov_b32 exec_hi, 0x1010101
L_can_41:
    buffer_load_dwordx4 v[136:139], v5, s[60:63], s40 offen sc1
    s_waitcnt vmcnt(0)
    v_xor_b32 v156, v136, v4
    v_and_b32 v156, s86, v156
    v_cmp_eq_u32 vcc, 0, v156
    s_cbranch_vccnz L_cand_42
    s_sleep 8
    s_sub_u32 s82, s82, 1
    s_cbranch_scc0 L_can_41
L_cand_42:
    s_mov_b64 exec, s[84:85]
L_poll_43:
    buffer_load_dwordx4 v[136:139], v5, s[60:63], s40 offen sc1
    buffer_load_dwordx4 v[140:143], v6, s[60:63], s40 offen sc1
    buffer_load_dwordx4 v[144:147], v5, s[60:63], s41 offen sc1
    buffer_load_dwordx4 v[148:151], v6, s[60:63], s41 offen sc1
    s_waitcnt vmcnt(3)
    v_bitop3_b32 v157, v136, v137, v4 bitop3:0x7e
    v_bitop3_b32 v158, v138, v139, v4 bitop3:0x7e
    v_or_b32 v156, v157, v158
    s_waitcnt vmcnt(2)
    v_bitop3_b32 v157, v140, v141, v4 bitop3:0x7e
    v_bitop3_b32 v158, v142, v143, v4 bitop3:0x7e
    v_or3_b32 v156, v156, v157, v158
    s_waitcnt vmcnt(1)
    v_bitop3_b32 v157, v144, v145, v4 bitop3:0x7e
    v_bitop3_b32 v158, v146, v147, v4 bitop3:0x7e
    v_or3_b32 v156, v156, v157, v158
    s_waitcnt vmcnt(0)
    v_bitop3_b32 v157, v148, v149, v4 bitop3:0x7e
    v_bitop3_b32 v158, v150, v151, v4 bitop3:0x7e
    v_or3_b32 v156, v156, v157, v158
    v_and_b32 v156, s86, v156
    v_cmp_ne_u32 vcc, 0, v156
    s_cbranch_vccz L_done_44
    s_mov_b64 exec, vcc
    s_sub_u32 s82, s82, 1
    s_cbranch_scc0 L_poll_43
L_done_44:
    s_mov_b64 exec, -1
    v_and_b32 v136, s88, v136
    v_and_b32 v137, s88, v137
    v_and_b32 v138, s88, v138
    v_and_b32 v139, s88, v139
    v_and_b32 v140, s88, v140
    v_and_b32 v141, s88, v141
    v_and_b32 v142, s88, v142
    v_and_b32 v143, s88, v143
    v_and_b32 v144, s88, v144
    v_and_b32 v145, s88, v145
    v_and_b32 v146, s88, v146
    v_and_b32 v147, s88, v147
    v_and_b32 v148, s88, v148
    v_and_b32 v149, s88, v149
    v_and_b32 v150, s88, v150
    v_and_b32 v151, s88, v151
    v_pk_mul_f32 v[136:137], v[152:153], v[136:137] op_sel:[0,0] op_sel_hi:[0,1]
    v_pk_mul_f32 v[138:139], v[152:153], v[138:139] op_sel:[0,0] op_sel_hi:[0,1]
    v_pk_mul_f32 v[144:145], v[154:155], v[144:145] op_sel:[0,0] op_sel_hi:[0,1]
    v_pk_mul_f32 v[146:147], v[154:155], v[146:147] op_sel:[0,0] op_sel_hi:[0,1]
    v_pk_fma_f32 v[136:137], v[152:153], v[140:141], v[136:137] op_sel:[1,0,0] op_sel_hi:[1,1,1]
    v_pk_fma_f32 v[138:139], v[152:153], v[142:143], v[138:139] op_sel:[1,0,0] op_sel_hi:[1,1,1]
    v_pk_fma_f32 v[144:145], v[154:155], v[148:149], v[144:145] op_sel:[1,0,0] op_sel_hi:[1,1,1]
    v_pk_fma_f32 v[146:147], v[154:155], v[150:151], v[146:147] op_sel:[1,0,0] op_sel_hi:[1,1,1]
    s_nop 0
    v_permlane32_swap_b32 v136, v144
    v_permlane32_swap_b32 v137, v145
    v_permlane32_swap_b32 v138, v146
    v_permlane32_swap_b32 v139, v147
    v_pk_add_f32 v[136:137], v[136:137], v[144:145]
    v_pk_add_f32 v[138:139], v[138:139], v[146:147]
    s_nop 1
    v_permlane16_swap_b32 v136, v138
    v_permlane16_swap_b32 v137, v139
    v_pk_add_f32 v[136:137], v[136:137], v[138:139]
    s_nop 1
    v_add_f32_dpp v136, v136, v136 row_ror:8 row_mask:0xf bank_mask:0xf
    v_add_f32_dpp v137, v137, v137 row_ror:8 row_mask:0xf bank_mask:0xf
    v_cvt_pk_bf16_f32 v136, v136, v137
    ds_write_b32 v3, v136
    v_mov_b32 v144, 0
    v_mov_b32 v145, 0
    v_mov_b32 v146, 0
    v_mov_b32 v147, 0
    v_mov_b32 v148, 0
    v_mov_b32 v149, 0
    v_mov_b32 v150, 0
    v_mov_b32 v151, 0
    s_waitcnt lgkmcnt(0)
    s_barrier
    ds_read_b128 v[136:139], v7 offset:0
    ds_read_b128 v[140:143], v7 offset:64
    v_mov_b32 v152, 0
    v_mov_b32 v153, 0
    v_mov_b32 v154, 0
    v_mov_b32 v155, 0
    v_mov_b32 v156, 0
    v_mov_b32 v157, 0
    v_mov_b32 v158, 0
    v_mov_b32 v159, 0
    s_waitcnt lgkmcnt(1)
    v_smfmac_f32_16x16x64_bf16 v[160:163], v[136:139], v[8:15], v1
    s_waitcnt lgkmcnt(0)
    v_smfmac_f32_16x16x64_bf16 v[160:163], v[140:143], v[72:79], v1
    v_smfmac_f32_16x16x64_bf16 v[144:147], v[136:139], v[16:23], v1
    v_smfmac_f32_16x16x64_bf16 v[144:147], v[140:143], v[80:87], v1
    v_smfmac_f32_16x16x64_bf16 v[148:151], v[136:139], v[24:31], v1
    v_smfmac_f32_16x16x64_bf16 v[148:151], v[140:143], v[88:95], v1
    v_smfmac_f32_16x16x64_bf16 v[152:155], v[136:139], v[32:39], v1
    v_smfmac_f32_16x16x64_bf16 v[152:155], v[140:143], v[96:103], v1
    s_nop 1
    v_add_f32_dpp v164, v160, v162 quad_perm:[0,1,2,3] row_mask:0x1 bank_mask:0xf
    v_add_f32_dpp v165, v161, v163 quad_perm:[0,1,2,3] row_mask:0x1 bank_mask:0xf
    v_mov_b32 v160, 0
    v_mov_b32 v161, 0
    v_mov_b32 v162, 0
    v_mov_b32 v163, 0
    v_smfmac_f32_16x16x64_bf16 v[156:159], v[136:139], v[40:47], v1
    v_smfmac_f32_16x16x64_bf16 v[156:159], v[140:143], v[104:111], v1
    v_add_f32_dpp v166, v144, v146 quad_perm:[0,1,2,3] row_mask:0x1 bank_mask:0xf
    v_add_f32_dpp v167, v145, v147 quad_perm:[0,1,2,3] row_mask:0x1 bank_mask:0xf
    v_mov_b32 v144, 0
    v_mov_b32 v145, 0
    v_mov_b32 v146, 0
    v_mov_b32 v147, 0
    v_smfmac_f32_16x16x64_bf16 v[160:163], v[136:139], v[48:55], v1
    v_smfmac_f32_16x16x64_bf16 v[160:163], v[140:143], v[112:119], v1
    v_add_f32_dpp v164, v148, v150 quad_perm:[0,1,2,3] row_mask:0x2 bank_mask:0xf
    v_add_f32_dpp v165, v149, v151 quad_perm:[0,1,2,3] row_mask:0x2 bank_mask:0xf
    v_mov_b32 v148, 0
    v_mov_b32 v149, 0
    v_mov_b32 v150, 0
    v_mov_b32 v151, 0
    v_smfmac_f32_16x16x64_bf16 v[144:147], v[136:139], v[56:63], v1
    v_smfmac_f32_16x16x64_bf16 v[144:147], v[140:143], v[120:127], v1
    v_add_f32_dpp v166, v152, v154 quad_perm:[0,1,2,3] row_mask:0x2 bank_mask:0xf
    v_add_f32_dpp v167, v153, v155 quad_perm:[0,1,2,3] row_mask:0x2 bank_mask:0xf
    v_smfmac_f32_16x16x64_bf16 v[148:151], v[136:139], v[64:71], v1
    v_smfmac_f32_16x16x64_bf16 v[148:151], v[140:143], v[128:135], v1
    v_add_f32_dpp v164, v156, v158 quad_perm:[0,1,2,3] row_mask:0x4 bank_mask:0xf
    v_add_f32_dpp v165, v157, v159 quad_perm:[0,1,2,3] row_mask:0x4 bank_mask:0xf
    v_add_f32_dpp v166, v160, v162 quad_perm:[0,1,2,3] row_mask:0x4 bank_mask:0xf
    v_add_f32_dpp v167, v161, v163 quad_perm:[0,1,2,3] row_mask:0x4 bank_mask:0xf
    v_add_f32_dpp v164, v144, v146 quad_perm:[0,1,2,3] row_mask:0x8 bank_mask:0xf
    v_add_f32_dpp v165, v145, v147 quad_perm:[0,1,2,3] row_mask:0x8 bank_mask:0xf
    s_nop 1
    v_add_f32_dpp v166, v148, v150 quad_perm:[0,1,2,3] row_mask:0x8 bank_mask:0xf
    v_add_f32_dpp v167, v149, v151 quad_perm:[0,1,2,3] row_mask:0x8 bank_mask:0xf
    s_mov_b32 exec_lo, s15
    s_mov_b32 exec_hi, s15
    s_cmp_eq_u32 s79, 1
    s_cbranch_scc0 L_rp_45
    buffer_store_dwordx4 v[164:167], v2, s[60:63], s42 offen
L_re_46:
    s_mov_b64 exec, -1
    s_cmp_lg_u32 s2, 31
    s_cbranch_scc1 L_o9
    s_cmp_lg_u32 s3, 0
    s_cbranch_scc1 L_o9
    v_mov_b32 v8, 0
    v_mov_b32 v9, s13
    s_mov_b32 s9, 0x12000
    s_mov_b32 s82, 0x61a80
    s_mov_b64 exec, 1
L_ep:
    s_sleep 4
    buffer_load_dword v10, v8, s[60:63], s9 offen sc1
    s_waitcnt vmcnt(0)
    v_cmp_eq_u32 vcc, -1, v10
    s_cbranch_vccz L_ep2
    s_sub_u32 s82, s82, 1
    s_cbranch_scc0 L_ep
L_ep2:
    buffer_store_dword v9, v8, s[60:63], 0 offen sc1
    s_mov_b64 exec, -1
L_o9:
    s_endpgm
L_fw:
    s_sub_u32 s11, s3, 4
    s_mov_b32 s64, s22
    s_and_b32 s65, s23, 0xffff
    s_mov_b32 s66, 0x380000
    s_mov_b32 s67, 0x00020000
    v_lshrrev_b32 v6, 4, v0
    v_mul_u32_u24 v1, 114688, v6
    v_and_b32 v7, 15, v0
    v_lshl_add_u32 v1, v7, 4, v1
    s_and_b32 s9, s2, 3
    s_lshl_b32 s9, s9, 1
    s_lshr_b32 s10, s11, 2
    s_add_u32 s14, s9, s10
    s_mov_b32 s14, s11
    s_mul_i32 s9, s14, 458752
    s_and_b32 s10, s2, 28
    s_and_b32 s12, s11, 3
    s_add_u32 s13, s10, s12
    s_mov_b32 s13, s2
    s_lshl_b32 s10, s13, 8
    s_add_u32 s9, s9, s10
    buffer_load_dwordx4 v[80:83], v1, s[64:67], s9 offen nt
    s_add_u32 s9, s9, 8192
    buffer_load_dwordx4 v[84:87], v1, s[64:67], s9 offen nt
    s_add_u32 s9, s9, 8192
    buffer_load_dwordx4 v[88:91], v1, s[64:67], s9 offen nt
    s_add_u32 s9, s9, 8192
    buffer_load_dwordx4 v[92:95], v1, s[64:67], s9 offen nt
    s_add_u32 s9, s9, 8192
    buffer_load_dwordx4 v[96:99], v1, s[64:67], s9 offen nt
    s_add_u32 s9, s9, 8192
    buffer_load_dwordx4 v[100:103], v1, s[64:67], s9 offen nt
    s_add_u32 s9, s9, 8192
    buffer_load_dwordx4 v[104:107], v1, s[64:67], s9 offen nt
    s_add_u32 s9, s9, 8192
    buffer_load_dwordx4 v[108:111], v1, s[64:67], s9 offen nt
    s_add_u32 s9, s9, 8192
    buffer_load_dwordx4 v[112:115], v1, s[64:67], s9 offen nt
    s_add_u32 s9, s9, 8192
    buffer_load_dwordx4 v[116:119], v1, s[64:67], s9 offen nt
    s_add_u32 s9, s9, 8192
    buffer_load_dwordx4 v[120:123], v1, s[64:67], s9 offen nt
    s_add_u32 s9, s9, 8192
    buffer_load_dwordx4 v[124:127], v1, s[64:67], s9 offen nt
    s_add_u32 s9, s9, 8192
    buffer_load_dwordx4 v[128:131], v1, s[64:67], s9 offen nt
    s_add_u32 s9, s9, 8192
    buffer_load_dwordx4 v[132:135], v1, s[64:67], s9 offen nt
    s_add_u32 s9, s9, 8192
    s_mov_b32 s64, s28
    s_and_b32 s65, s29, 0xffff
    s_mov_b32 s66, 0x188000
    s_mov_b32 s67, 0x00020000
    s_mov_b32 s72, s30
    s_and_b32 s73, s31, 0xffff
    s_mov_b32 s74, 0x188000
    s_mov_b32 s75, 0x00020000
    v_bfe_u32 v1, v0, 1, 3
    v_and_b32 v24, 1, v1
    v_lshlrev_b32 v24, 4, v24
    v_mov_b32 v25, 0xffff
    v_lshlrev_b32 v24, v24, v25
    v_lshrrev_b32 v25, 1, v1
    v_cmp_eq_u32 vcc, 0, v25
    s_nop 1
    v_cndmask_b32 v20, 0, v24, vcc
    v_cmp_eq_u32 vcc, 1, v25
    s_nop 1
    v_cndmask_b32 v21, 0, v24, vcc
    v_cmp_eq_u32 vcc, 2, v25
    s_nop 1
    v_cndmask_b32 v22, 0, v24, vcc
    v_cmp_eq_u32 vcc, 3, v25
    s_nop 1
    v_cndmask_b32 v23, 0, v24, vcc
    v_lshlrev_b32 v8, 4, v0
    s_lshl_b32 s9, s11, 10
    s_add_u32 s9, s9, 155648
    v_add_u32 v8, s9, v8
    v_mov_b32 v9, 119568
    v_and_b32 v10, 15, v0
    v_lshlrev_b32 v10, 6, v10
    v_lshl_add_u32 v10, v6, 4, v10
    v_and_b32 v1, 1, v0
    v_mul_u32_u24 v18, 896, v1
    v_mul_u32_u24 v1, 28, v6
    v_add_u32 v1, v1, v18
    s_mul_i32 s9, s14, 112
    s_add_u32 s9, s9, 114688
    v_add_u32 v1, s9, v1
    v_lshl_add_u32 v18, v6, 4, v18
    v_bfe_u32 v7, v0, 1, 1
    v_mul_u32_u24 v19, 0xaaaa, v7
    v_add_u32 v19, 0x4444, v19
    v_mul_u32_u24 v7, 448, v7
    v_add_u32 v18, v18, v7
    v_add_u32 v18, 116736, v18
    s_mov_b32 s46, 0x01000100
    s_mov_b32 s47, 0x03020302
    v_mov_b32 v7, 1
    s_mov_b64 exec, 1
    ds_add_u32 v9, v7 offset:8
    s_mov_b64 exec, -1
    s_mov_b32 s10, 0x30d400
L_lw_47:
    ds_read_b32 v7, v9 offset:0
    s_waitcnt lgkmcnt(0)
    v_readfirstlane_b32 s9, v7
    s_nop 0
    s_cmp_ge_u32 s9, 1
    s_cbranch_scc1 L_lwd_48
    s_sleep 2
    s_sub_u32 s10, s10, 1
    s_cbranch_scc0 L_lw_47
L_lwd_48:
    ds_read_b32 v24, v1 offset:0
    ds_read_b32 v25, v1 offset:4
    ds_read_b32 v26, v1 offset:8
    ds_read_b32 v27, v1 offset:12
    ds_read_b32 v28, v1 offset:16
    ds_read_b32 v29, v1 offset:20
    ds_read_b32 v30, v1 offset:24
    s_waitcnt lgkmcnt(0)
    v_perm_b32 v1, v24, v24, s46
    v_and_b32 v32, v1, v20
    v_and_b32 v33, v1, v21
    v_and_b32 v34, v1, v22
    v_and_b32 v35, v1, v23
    s_waitcnt vmcnt(13)
    s_nop 0
    v_mfma_f32_16x16x32_bf16 v[40:43], v[32:35], v[80:83], 0
    v_perm_b32 v1, v24, v24, s47
    v_and_b32 v36, v1, v20
    v_and_b32 v37, v1, v21
    v_and_b32 v38, v1, v22
    v_and_b32 v39, v1, v23
    s_waitcnt vmcnt(12)
    s_nop 0
    v_mfma_f32_16x16x32_bf16 v[40:43], v[36:39], v[84:87], v[40:43]
    v_perm_b32 v1, v25, v25, s46
    v_and_b32 v32, v1, v20
    v_and_b32 v33, v1, v21
    v_and_b32 v34, v1, v22
    v_and_b32 v35, v1, v23
    s_waitcnt vmcnt(11)
    s_nop 0
    v_mfma_f32_16x16x32_bf16 v[40:43], v[32:35], v[88:91], v[40:43]
    v_perm_b32 v1, v25, v25, s47
    v_and_b32 v36, v1, v20
    v_and_b32 v37, v1, v21
    v_and_b32 v38, v1, v22
    v_and_b32 v39, v1, v23
    s_waitcnt vmcnt(10)
    s_nop 0
    v_mfma_f32_16x16x32_bf16 v[40:43], v[36:39], v[92:95], v[40:43]
    v_perm_b32 v1, v26, v26, s46
    v_and_b32 v32, v1, v20
    v_and_b32 v33, v1, v21
    v_and_b32 v34, v1, v22
    v_and_b32 v35, v1, v23
    s_waitcnt vmcnt(9)
    s_nop 0
    v_mfma_f32_16x16x32_bf16 v[40:43], v[32:35], v[96:99], v[40:43]
    v_perm_b32 v1, v26, v26, s47
    v_and_b32 v36, v1, v20
    v_and_b32 v37, v1, v21
    v_and_b32 v38, v1, v22
    v_and_b32 v39, v1, v23
    s_waitcnt vmcnt(8)
    s_nop 0
    v_mfma_f32_16x16x32_bf16 v[40:43], v[36:39], v[100:103], v[40:43]
    v_perm_b32 v1, v27, v27, s46
    v_and_b32 v32, v1, v20
    v_and_b32 v33, v1, v21
    v_and_b32 v34, v1, v22
    v_and_b32 v35, v1, v23
    s_waitcnt vmcnt(7)
    s_nop 0
    v_mfma_f32_16x16x32_bf16 v[40:43], v[32:35], v[104:107], v[40:43]
    v_perm_b32 v1, v27, v27, s47
    v_and_b32 v36, v1, v20
    v_and_b32 v37, v1, v21
    v_and_b32 v38, v1, v22
    v_and_b32 v39, v1, v23
    s_waitcnt vmcnt(6)
    s_nop 0
    v_mfma_f32_16x16x32_bf16 v[40:43], v[36:39], v[108:111], v[40:43]
    v_perm_b32 v1, v28, v28, s46
    v_and_b32 v32, v1, v20
    v_and_b32 v33, v1, v21
    v_and_b32 v34, v1, v22
    v_and_b32 v35, v1, v23
    s_waitcnt vmcnt(5)
    s_nop 0
    v_mfma_f32_16x16x32_bf16 v[40:43], v[32:35], v[112:115], v[40:43]
    v_perm_b32 v1, v28, v28, s47
    v_and_b32 v36, v1, v20
    v_and_b32 v37, v1, v21
    v_and_b32 v38, v1, v22
    v_and_b32 v39, v1, v23
    s_waitcnt vmcnt(4)
    s_nop 0
    v_mfma_f32_16x16x32_bf16 v[40:43], v[36:39], v[116:119], v[40:43]
    v_perm_b32 v1, v29, v29, s46
    v_and_b32 v32, v1, v20
    v_and_b32 v33, v1, v21
    v_and_b32 v34, v1, v22
    v_and_b32 v35, v1, v23
    s_waitcnt vmcnt(3)
    s_nop 0
    v_mfma_f32_16x16x32_bf16 v[40:43], v[32:35], v[120:123], v[40:43]
    v_perm_b32 v1, v29, v29, s47
    v_and_b32 v36, v1, v20
    v_and_b32 v37, v1, v21
    v_and_b32 v38, v1, v22
    v_and_b32 v39, v1, v23
    s_waitcnt vmcnt(2)
    s_nop 0
    v_mfma_f32_16x16x32_bf16 v[40:43], v[36:39], v[124:127], v[40:43]
    v_perm_b32 v1, v30, v30, s46
    v_and_b32 v32, v1, v20
    v_and_b32 v33, v1, v21
    v_and_b32 v34, v1, v22
    v_and_b32 v35, v1, v23
    s_waitcnt vmcnt(1)
    s_nop 0
    v_mfma_f32_16x16x32_bf16 v[40:43], v[32:35], v[128:131], v[40:43]
    v_perm_b32 v1, v30, v30, s47
    v_and_b32 v36, v1, v20
    v_and_b32 v37, v1, v21
    v_and_b32 v38, v1, v22
    v_and_b32 v39, v1, v23
    s_waitcnt vmcnt(0)
    s_nop 0
    v_mfma_f32_16x16x32_bf16 v[40:43], v[36:39], v[132:135], v[40:43]
    v_add_u32 v3, 1, v3
    v_and_b32 v4, s86, v3
    v_and_b32 v5, s87, v3
    s_nop 4
    ds_write_b128 v8, v[40:43]
    v_mov_b32 v7, 1
    s_mov_b64 exec, 1
    ds_add_u32 v9, v7 offset:4
    s_mov_b64 exec, -1
    s_cmp_lg_u32 s11, 0
    s_cbranch_scc1 L_f1
    s_setprio 3
    s_mov_b32 s10, 0x30d400
L_lw_49:
    ds_read_b32 v7, v9 offset:4
    s_waitcnt lgkmcnt(0)
    v_readfirstlane_b32 s9, v7
    s_nop 0
    s_cmp_ge_u32 s9, 8
    s_cbranch_scc1 L_lwd_50
    s_sleep 2
    s_sub_u32 s10, s10, 1
    s_cbranch_scc0 L_lw_49
L_lwd_50:
    ds_read_b128 v[24:27], v8 offset:0
    ds_read_b128 v[28:31], v8 offset:1024
    ds_read_b128 v[32:35], v8 offset:2048
    ds_read_b128 v[36:39], v8 offset:3072
    ds_read_b128 v[40:43], v8 offset:4096
    ds_read_b128 v[44:47], v8 offset:5120
    ds_read_b128 v[48:51], v8 offset:6144
    ds_read_b128 v[52:55], v8 offset:7168
    v_lshrrev_b32 v1, 1, v10
    s_lshl_b32 s9, s2, 9
    s_add_u32 s9, s9, 0xe0000
    s_add_u32 s10, s9, 16384
    s_waitcnt lgkmcnt(0)
    v_pk_add_f32 v[24:25], v[24:25], v[28:29]
    v_pk_add_f32 v[26:27], v[26:27], v[30:31]
    v_pk_add_f32 v[24:25], v[24:25], v[32:33]
    v_pk_add_f32 v[26:27], v[26:27], v[34:35]
    v_pk_add_f32 v[24:25], v[24:25], v[36:37]
    v_pk_add_f32 v[26:27], v[26:27], v[38:39]
    v_pk_add_f32 v[24:25], v[24:25], v[40:41]
    v_pk_add_f32 v[26:27], v[26:27], v[42:43]
    v_pk_add_f32 v[24:25], v[24:25], v[44:45]
    v_pk_add_f32 v[26:27], v[26:27], v[46:47]
    v_pk_add_f32 v[24:25], v[24:25], v[48:49]
    v_pk_add_f32 v[26:27], v[26:27], v[50:51]
    v_pk_add_f32 v[24:25], v[24:25], v[52:53]
    v_pk_add_f32 v[26:27], v[26:27], v[54:55]
    v_cvt_pk_bf16_f32 v28, v24, v26
    v_cvt_pk_bf16_f32 v29, v25, v27
    v_lshl_or_b32 v30, v28, 16, v5
    v_and_b32 v31, 0xffff0000, v28
    v_or_b32 v31, v31, v5
    v_lshl_or_b32 v32, v29, 16, v5
    v_and_b32 v33, 0xffff0000, v29
    v_or_b32 v33, v33, v5
    buffer_store_dwordx2 v[30:31], v1, s[60:63], s9 offen sc1
    buffer_store_dwordx2 v[32:33], v1, s[60:63], s10 offen sc1
    v_mov_b32 v7, 1
    s_mov_b64 exec, 1
    ds_add_u32 v9, v7 offset:12
    s_mov_b64 exec, -1
L_f1:
    s_mov_b32 s10, 0x30d400
L_lw_51:
    ds_read_b32 v7, v9 offset:12
    s_waitcnt lgkmcnt(0)
    v_readfirstlane_b32 s9, v7
    s_nop 0
    s_cmp_ge_u32 s9, 1
    s_cbranch_scc1 L_lwd_52
    s_sleep 2
    s_sub_u32 s10, s10, 1
    s_cbranch_scc0 L_lw_51
L_lwd_52:
    s_setprio 0
    v_mov_b32 v11, 0
    s_cmp_ge_u32 s2, 28
    s_cbranch_scc1 L_fin
    v_lshrrev_b32 v1, 3, v0
    v_mul_u32_u24 v1, 3584, v1
    v_and_b32 v7, 7, v0
    v_lshl_add_u32 v11, v7, 4, v1
    s_mul_i32 s9, s11, 200704
    s_lshl_b32 s10, s2, 7
    s_add_u32 s9, s9, s10
    s_mul_i32 s10, s11, 7168
    s_mov_b32 m0, s10
    s_add_u32 s12, s10, 57344
    s_waitcnt vmcnt(2)
    buffer_load_dwordx4 v11, s[64:67], s9 offen nt lds
    s_mov_b32 m0, s12
    s_add_u32 s10, s10, 1024
    s_waitcnt vmcnt(2)
    buffer_load_dwordx4 v11, s[72:75], s9 offen nt lds
    s_add_u32 s9, s9, 28672
    s_mov_b32 m0, s10
    s_add_u32 s12, s10, 57344
    s_waitcnt vmcnt(2)
    buffer_load_dwordx4 v11, s[64:67], s9 offen nt lds
    s_mov_b32 m0, s12
    s_add_u32 s10, s10, 1024
    s_waitcnt vmcnt(2)
    buffer_load_dwordx4 v11, s[72:75], s9 offen nt lds
    s_add_u32 s9, s9, 28672
    s_mov_b32 m0, s10
    s_add_u32 s12, s10, 57344
    s_waitcnt vmcnt(2)
    buffer_load_dwordx4 v11, s[64:67], s9 offen nt lds
    s_mov_b32 m0, s12
    s_add_u32 s10, s10, 1024
    s_waitcnt vmcnt(2)
    buffer_load_dwordx4 v11, s[72:75], s9 offen nt lds
    s_add_u32 s9, s9, 28672
    s_mov_b32 m0, s10
    s_add_u32 s12, s10, 57344
    s_waitcnt vmcnt(2)
    buffer_load_dwordx4 v11, s[64:67], s9 offen nt lds
    s_mov_b32 m0, s12
    s_add_u32 s10, s10, 1024
    s_waitcnt vmcnt(2)
    buffer_load_dwordx4 v11, s[72:75], s9 offen nt lds
    s_add_u32 s9, s9, 28672
    s_mov_b32 m0, s10
    s_add_u32 s12, s10, 57344
    s_waitcnt vmcnt(2)
    buffer_load_dwordx4 v11, s[64:67], s9 offen nt lds
    s_mov_b32 m0, s12
    s_add_u32 s10, s10, 1024
    s_waitcnt vmcnt(2)
    buffer_load_dwordx4 v11, s[72:75], s9 offen nt lds
    s_add_u32 s9, s9, 28672
    s_mov_b32 m0, s10
    s_add_u32 s12, s10, 57344
    s_waitcnt vmcnt(2)
    buffer_load_dwordx4 v11, s[64:67], s9 offen nt lds
    s_mov_b32 m0, s12
    s_add_u32 s10, s10, 1024
    s_waitcnt vmcnt(2)
    buffer_load_dwordx4 v11, s[72:75], s9 offen nt lds
    s_add_u32 s9, s9, 28672
    s_mov_b32 m0, s10
    s_add_u32 s12, s10, 57344
    s_waitcnt vmcnt(2)
    buffer_load_dwordx4 v11, s[64:67], s9 offen nt lds
    s_mov_b32 m0, s12
    s_add_u32 s10, s10, 1024
    s_waitcnt vmcnt(2)
    buffer_load_dwordx4 v11, s[72:75], s9 offen nt lds
    s_add_u32 s9, s9, 28672
    s_mov_b32 s64, s32
    s_and_b32 s65, s33, 0xffff
    s_mov_b32 s66, 0x188000
    s_mov_b32 s67, 0x00020000
    v_lshrrev_b32 v6, 4, v0
    v_mul_u32_u24 v1, 7168, v6
    v_and_b32 v7, 15, v0
    v_lshl_add_u32 v1, v7, 4, v1
    s_mul_i32 s9, s2, 57344
    s_lshr_b32 s10, s11, 1
    s_lshl_b32 s14, s10, 10
    s_cmp_eq_u32 s10, 3
    s_cselect_b32 s15, 0x00ff00ff, -1
    s_lshl_b32 s10, s10, 8
    s_add_u32 s9, s9, s10
    s_and_b32 s10, s11, 1
    s_mul_i32 s12, s10, 28672
    s_add_u32 s9, s9, s12
    s_lshl_b32 s10, s10, 5
    s_add_u32 s14, s14, s10
    s_mov_b32 exec_lo, s15
    s_mov_b32 exec_hi, s15
    s_waitcnt vmcnt(2)
    buffer_load_dwordx4 v[24:27], v1, s[64:67], s9 offen offset:0 nt
    s_waitcnt vmcnt(2)
    buffer_load_dwordx4 v[28:31], v1, s[64:67], s9 offen offset:896 nt
    s_waitcnt vmcnt(2)
    buffer_load_dwordx4 v[32:35], v1, s[64:67], s9 offen offset:1792 nt
    s_waitcnt vmcnt(2)
    buffer_load_dwordx4 v[36:39], v1, s[64:67], s9 offen offset:2688 nt
    s_add_u32 s9, s9, 3584
    s_waitcnt vmcnt(2)
    buffer_load_dwordx4 v[40:43], v1, s[64:67], s9 offen offset:0 nt
    s_waitcnt vmcnt(2)
    buffer_load_dwordx4 v[44:47], v1, s[64:67], s9 offen offset:896 nt
    s_waitcnt vmcnt(2)
    buffer_load_dwordx4 v[48:51], v1, s[64:67], s9 offen offset:1792 nt
    s_waitcnt vmcnt(2)
    buffer_load_dwordx4 v[52:55], v1, s[64:67], s9 offen offset:2688 nt
    s_mov_b64 exec, -1
    v_bfe_u32 v7, v0, 3, 1
    v_lshlrev_b32 v20, 7, v7
    v_bfe_u32 v7, v0, 1, 1
    v_lshl_add_u32 v20, v7, 6, v20
    v_lshlrev_b32 v21, 6, v7
    v_bfe_u32 v7, v0, 2, 1
    v_lshl_add_u32 v20, v7, 2, v20
    v_and_b32 v7, 1, v0
    v_lshl_add_u32 v20, v7, 1, v20
    v_lshl_add_u32 v21, v7, 7, v21
    s_lshl_b32 s9, s11, 3
    s_add_u32 s9, s9, 119296
    v_add_u32 v20, s9, v20
    v_lshl_add_u32 v21, v6, 4, v21
    v_add_u32 v21, 119296, v21
    v_bfe_u32 v7, v0, 4, 1
    v_mul_u32_u24 v14, 896, v7
    v_lshlrev_b32 v13, 6, v7
    v_and_b32 v7, 7, v0
    v_lshl_add_u32 v14, v7, 2, v14
    v_lshl_add_u32 v13, v7, 3, v13
    v_lshrrev_b32 v7, 5, v0
    v_lshl_add_u32 v14, v7, 1, v14
    v_lshl_add_u32 v13, v7, 2, v13
    s_lshl_b32 s43, s2, 5
    v_lshlrev_b32 v13, 1, v14
    buffer_load_ushort v15, v14, s[56:59], s43 offen
    v_lshrrev_b32 v6, 4, v0
    v_lshlrev_b32 v6, 10, v6
    v_bfe_u32 v7, v0, 2, 2
    v_lshl_add_u32 v6, v7, 7, v6
    v_and_b32 v7, 1, v0
    v_lshl_add_u32 v6, v7, 3, v6
    v_bfe_u32 v7, v0, 1, 1
    v_mul_u32_u24 v7, 57344, v7
    v_add_u32 v6, v6, v7
    s_lshl_b32 s9, s11, 4
    v_add_u32 v6, s9, v6
    v_subrev_u32 v12, 14336, v11
    v_cmp_gt_u32 vcc, 32, v0
    s_nop 1
    v_cndmask_b32 v12, v12, v11, vcc
    s_lshl_b32 s9, s2, 7
    s_add_u32 s44, s9, 0xa0000
    s_add_u32 s28, s9, 0xc0000
    s_add_u32 s45, s9, 0xa7000
    s_add_u32 s29, s9, 0xc7000
    s_add_u32 s12, s9, 0xae000
    s_add_u32 s30, s9, 0xce000
    s_add_u32 s13, s9, 0xb5000
    s_add_u32 s31, s9, 0xd5000
    s_lshl_b32 s40, s2, 6
    s_add_u32 s40, s40, 0x12000
    v_lshlrev_b32 v17, 4, v0
    v_lshlrev_b32 v16, 2, v0
    s_cmp_eq_u32 s11, 6
    s_cselect_b32 s9, 896, 0
    s_cselect_b32 s41, 1792, 0
    s_add_u32 s9, s9, 116736
    v_add_u32 v16, s9, v16
    s_add_u32 s41, s41, 0x12000
    s_mul_i32 s42, s2, 3584
    s_add_u32 s42, s42, s14
    s_add_u32 s42, s42, 0xc0000
    s_mov_b32 s80, -1
    s_mov_b32 s81, 0x00ffffff
    s_mov_b32 s46, 0x05040100
    s_mov_b32 s47, 0x07060302
    s_mov_b32 s76, 0x3d372713
    s_mov_b32 s77, 0xc0135761
    s_cmp_lg_u32 s11, 7
    s_cbranch_scc1 L_nt
    s_mov_b32 exec_lo, 0xff00ff
    s_mov_b32 exec_hi, 0xff00ff
    buffer_store_short v2, v14, s[68:71], s43 offen
    s_mov_b64 exec, -1
    buffer_load_dwordx4 v[56:59], v11, s[60:63], s44 offen sc1
    buffer_load_dwordx4 v[60:63], v11, s[60:63], s45 offen sc1
    buffer_load_dwordx4 v[64:67], v11, s[60:63], s12 offen sc1
    buffer_load_dwordx4 v[68:71], v11, s[60:63], s13 offen sc1
    buffer_load_dwordx4 v[72:75], v11, s[60:63], s28 offen sc1
    buffer_load_dwordx4 v[76:79], v11, s[60:63], s29 offen sc1
    buffer_load_dwordx4 v[56:59], v11, s[60:63], s30 offen sc1
    buffer_load_dwordx4 v[60:63], v11, s[60:63], s31 offen sc1
    buffer_load_dwordx4 v[64:67], v17, s[60:63], s41 offen offset:0 sc1
    buffer_load_dwordx4 v[68:71], v17, s[60:63], s41 offen offset:1024 sc1
    buffer_load_dwordx4 v[72:75], v17, s[60:63], s41 offen offset:2048 sc1
    buffer_load_dwordx4 v[76:79], v17, s[60:63], s41 offen offset:3072 sc1
L_nt:
    s_waitcnt vmcnt(0)
    v_lshlrev_b32 v1, 4, v0
    s_lshl_b32 s9, s11, 12
    s_add_u32 s9, s9, 122880
    v_add_u32 v7, s9, v1
    s_xor_b32 s9, s11, 1
    s_lshl_b32 s9, s9, 12
    s_add_u32 s9, s9, 122880
    v_add_u32 v1, s9, v1
    s_bitcmp1_b32 s11, 0
    s_cbranch_scc1 L_wx1
    v_perm_b32 v136, v28, v24, s46
    v_perm_b32 v137, v36, v32, s46
    v_perm_b32 v138, v44, v40, s46
    v_perm_b32 v139, v52, v48, s46
    v_perm_b32 v144, v28, v24, s47
    v_perm_b32 v145, v36, v32, s47
    v_perm_b32 v146, v44, v40, s47
    v_perm_b32 v147, v52, v48, s47
    v_perm_b32 v152, v29, v25, s46
    v_perm_b32 v153, v37, v33, s46
    v_perm_b32 v154, v45, v41, s46
    v_perm_b32 v155, v53, v49, s46
    v_perm_b32 v160, v29, v25, s47
    v_perm_b32 v161, v37, v33, s47
    v_perm_b32 v162, v45, v41, s47
    v_perm_b32 v163, v53, v49, s47
    v_perm_b32 v56, v30, v26, s46
    v_perm_b32 v57, v38, v34, s46
    v_perm_b32 v58, v46, v42, s46
    v_perm_b32 v59, v54, v50, s46
    v_perm_b32 v60, v30, v26, s47
    v_perm_b32 v61, v38, v34, s47
    v_perm_b32 v62, v46, v42, s47
    v_perm_b32 v63, v54, v50, s47
    v_perm_b32 v64, v31, v27, s46
    v_perm_b32 v65, v39, v35, s46
    v_perm_b32 v66, v47, v43, s46
    v_perm_b32 v67, v55, v51, s46
    v_perm_b32 v68, v31, v27, s47
    v_perm_b32 v69, v39, v35, s47
    v_perm_b32 v70, v47, v43, s47
    v_perm_b32 v71, v55, v51, s47
    s_branch L_wx2
L_wx1:
    v_perm_b32 v56, v28, v24, s46
    v_perm_b32 v57, v36, v32, s46
    v_perm_b32 v58, v44, v40, s46
    v_perm_b32 v59, v52, v48, s46
    v_perm_b32 v60, v28, v24, s47
    v_perm_b32 v61, v36, v32, s47
    v_perm_b32 v62, v44, v40, s47
    v_perm_b32 v63, v52, v48, s47
    v_perm_b32 v64, v29, v25, s46
    v_perm_b32 v65, v37, v33, s46
    v_perm_b32 v66, v45, v41, s46
    v_perm_b32 v67, v53, v49, s46
    v_perm_b32 v68, v29, v25, s47
    v_perm_b32 v69, v37, v33, s47
    v_perm_b32 v70, v45, v41, s47
    v_perm_b32 v71, v53, v49, s47
    v_perm_b32 v140, v30, v26, s46
    v_perm_b32 v141, v38, v34, s46
    v_perm_b32 v142, v46, v42, s46
    v_perm_b32 v143, v54, v50, s46
    v_perm_b32 v148, v30, v26, s47
    v_perm_b32 v149, v38, v34, s47
    v_perm_b32 v150, v46, v42, s47
    v_perm_b32 v151, v54, v50, s47
    v_perm_b32 v156, v31, v27, s46
    v_perm_b32 v157, v39, v35, s46
    v_perm_b32 v158, v47, v43, s46
    v_perm_b32 v159, v55, v51, s46
    v_perm_b32 v164, v31, v27, s47
    v_perm_b32 v165, v39, v35, s47
    v_perm_b32 v166, v47, v43, s47
    v_perm_b32 v167, v55, v51, s47
L_wx2:
    ds_write_b128 v7, v[56:59] offset:0
    ds_write_b128 v7, v[60:63] offset:1024
    ds_write_b128 v7, v[64:67] offset:2048
    ds_write_b128 v7, v[68:71] offset:3072
    s_waitcnt lgkmcnt(0)
    s_barrier
    s_bitcmp1_b32 s11, 0
    s_cbranch_scc1 L_wr1
    ds_read_b128 v[140:143], v1 offset:0
    ds_read_b128 v[148:151], v1 offset:1024
    ds_read_b128 v[156:159], v1 offset:2048
    ds_read_b128 v[164:167], v1 offset:3072
    s_branch L_wr2
L_wr1:
    ds_read_b128 v[136:139], v1 offset:0
    ds_read_b128 v[144:147], v1 offset:1024
    ds_read_b128 v[152:155], v1 offset:2048
    ds_read_b128 v[160:163], v1 offset:3072
L_wr2:
    ds_read_b64_tr_b16 v[80:81], v6 offset:0
    ds_read_b64_tr_b16 v[82:83], v6 offset:512
    ds_read_b64_tr_b16 v[84:85], v6 offset:4096
    ds_read_b64_tr_b16 v[86:87], v6 offset:4608
    ds_read_b64_tr_b16 v[88:89], v6 offset:8192
    ds_read_b64_tr_b16 v[90:91], v6 offset:8704
    ds_read_b64_tr_b16 v[92:93], v6 offset:12288
    ds_read_b64_tr_b16 v[94:95], v6 offset:12800
    ds_read_b64_tr_b16 v[96:97], v6 offset:16384
    ds_read_b64_tr_b16 v[98:99], v6 offset:16896
    ds_read_b64_tr_b16 v[100:101], v6 offset:20480
    ds_read_b64_tr_b16 v[102:103], v6 offset:20992
    ds_read_b64_tr_b16 v[104:105], v6 offset:24576
    ds_read_b64_tr_b16 v[106:107], v6 offset:25088
    ds_read_b64_tr_b16 v[108:109], v6 offset:28672
    ds_read_b64_tr_b16 v[110:111], v6 offset:29184
    ds_read_b64_tr_b16 v[112:113], v6 offset:32768
    ds_read_b64_tr_b16 v[114:115], v6 offset:33280
    ds_read_b64_tr_b16 v[116:117], v6 offset:36864
    ds_read_b64_tr_b16 v[118:119], v6 offset:37376
    ds_read_b64_tr_b16 v[120:121], v6 offset:40960
    ds_read_b64_tr_b16 v[122:123], v6 offset:41472
    ds_read_b64_tr_b16 v[124:125], v6 offset:45056
    ds_read_b64_tr_b16 v[126:127], v6 offset:45568
    ds_read_b64_tr_b16 v[128:129], v6 offset:49152
    ds_read_b64_tr_b16 v[130:131], v6 offset:49664
    ds_read_b64_tr_b16 v[132:133], v6 offset:53248
    ds_read_b64_tr_b16 v[134:135], v6 offset:53760
    v_lshlrev_b32 v15, 16, v15
    v_mov_b32 v24, 119552
    ds_read_b32 v24, v24
    s_waitcnt lgkmcnt(0)
    v_readfirstlane_b32 s79, v24
    v_mov_b32 v24, 0
    v_mov_b32 v25, 0
    v_mov_b32 v26, 0
    v_mov_b32 v27, 0
    v_mov_b32 v28, 0
    v_mov_b32 v29, 0
    v_mov_b32 v30, 0
    v_mov_b32 v31, 0
    v_mov_b32 v32, 0
    v_mov_b32 v33, 0
    v_mov_b32 v34, 0
    v_mov_b32 v35, 0
    v_mov_b32 v36, 0
    v_mov_b32 v37, 0
    v_mov_b32 v38, 0
    v_mov_b32 v39, 0
    s_waitcnt lgkmcnt(0)
    s_barrier
    s_cmp_lt_u32 s11, 6
    s_cbranch_scc1 L_F2
    s_cmp_eq_u32 s11, 6
    s_cbranch_scc1 L_F1
    s_mov_b32 s82, 0x61a80
L_sp_53:
    buffer_load_dwordx4 v[40:43], v11, s[60:63], s44 offen sc1
    buffer_load_dwordx4 v[44:47], v11, s[60:63], s45 offen sc1
    buffer_load_dwordx4 v[48:51], v11, s[60:63], s12 offen sc1
    buffer_load_dwordx4 v[52:55], v11, s[60:63], s13 offen sc1
    s_waitcnt vmcnt(3)
    v_max3_u32 v72, v40, v41, v42
    v_max_u32 v72, v72, v43
    s_waitcnt vmcnt(2)
    v_max3_u32 v72, v72, v44, v45
    v_max3_u32 v72, v72, v46, v47
    s_waitcnt vmcnt(1)
    v_max3_u32 v72, v72, v48, v49
    v_max3_u32 v72, v72, v50, v51
    s_waitcnt vmcnt(0)
    v_max3_u32 v72, v72, v52, v53
    v_max3_u32 v72, v72, v54, v55
    v_cmp_eq_u32 vcc, -1, v72
    s_cbranch_vccz L_spd_54
    s_mov_b64 exec, vcc
    s_sub_u32 s82, s82, 1
    s_cbranch_scc0 L_sp_53
L_spd_54:
    s_mov_b64 exec, -1
    v_pk_add_f32 v[40:41], v[40:41], v[44:45]
    v_pk_add_f32 v[42:43], v[42:43], v[46:47]
    v_pk_add_f32 v[48:49], v[48:49], v[52:53]
    v_pk_add_f32 v[50:51], v[50:51], v[54:55]
    v_pk_add_f32 v[40:41], v[40:41], v[48:49]
    v_pk_add_f32 v[42:43], v[42:43], v[50:51]
    s_nop 1
    v_permlane32_swap_b32 v40, v42
    v_permlane32_swap_b32 v41, v43
    v_pk_add_f32 v[40:41], v[40:41], v[42:43]
    s_nop 1
    v_permlane16_swap_b32 v40, v41
    v_add_f32 v40, v40, v41
    s_nop 1
    v_add_f32_dpp v40, v40, v40 row_ror:8 row_mask:0xf bank_mask:0xf
    v_cvt_pk_bf16_f32 v40, v40, v40
    v_and_b32 v40, 0xffff0000, v40
    v_add_f32 v15, v15, v40
    v_cvt_pk_bf16_f32 v15, v15, v15
    v_and_b32 v15, 0xffff0000, v15
    s_mov_b32 exec_lo, 0xff00ff
    s_mov_b32 exec_hi, 0xff00ff
    s_cmp_eq_u32 s79, 1
    s_cbranch_scc0 L_rp_55
    buffer_store_dword v15, v13, s[60:63], s40 offen
L_re_56:
L_F1:
    s_mov_b64 exec, s[80:81]
    s_mov_b32 s82, 0x61a80
L_sp_57:
    buffer_load_dwordx4 v[24:27], v17, s[60:63], s41 offen offset:0 sc1
    buffer_load_dwordx4 v[28:31], v17, s[60:63], s41 offen offset:896 sc1
    s_waitcnt vmcnt(1)
    v_max3_u32 v72, v24, v25, v26
    v_max_u32 v72, v72, v27
    s_waitcnt vmcnt(0)
    v_max3_u32 v72, v72, v28, v29
    v_max3_u32 v72, v72, v30, v31
    v_cmp_eq_u32 vcc, -1, v72
    s_cbranch_vccz L_spd_58
    s_mov_b64 exec, vcc
    s_sub_u32 s82, s82, 1
    s_cbranch_scc0 L_sp_57
L_spd_58:
    s_mov_b64 exec, -1
    v_pk_add_f32 v[40:41], v[24:25], v[26:27]
    v_pk_add_f32 v[42:43], v[28:29], v[30:31]
    v_pk_add_f32 v[40:41], v[40:41], v[42:43]
    v_add_f32 v64, v40, v41
    s_nop 1
    v_add_f32_dpp v64, v64, v64 quad_perm:[1,0,3,2] row_mask:0xf bank_mask:0xf
    s_nop 1
    v_add_f32_dpp v64, v64, v64 quad_perm:[2,3,0,1] row_mask:0xf bank_mask:0xf
    s_nop 1
    v_add_f32_dpp v64, v64, v64 row_ror:8 row_mask:0xf bank_mask:0xf
    s_nop 1
    v_add_f32_dpp v64, v64, v64 row_ror:4 row_mask:0xf bank_mask:0xf
    v_mov_b32 v65, v64
    s_nop 1
    v_permlane16_swap_b32 v64, v65
    v_add_f32 v64, v64, v65
    v_mov_b32 v65, v64
    s_nop 1
    v_permlane32_swap_b32 v64, v65
    v_add_f32 v64, v64, v65
    v_mul_f32 v64, 0xbb124925, v64
    v_pk_add_f32 v[40:41], v[24:25], v[64:65] op_sel_hi:[1,0]
    v_pk_add_f32 v[42:43], v[26:27], v[64:65] op_sel_hi:[1,0]
    v_pk_add_f32 v[44:45], v[28:29], v[64:65] op_sel_hi:[1,0]
    v_pk_add_f32 v[46:47], v[30:31], v[64:65] op_sel_hi:[1,0]
    v_pk_mul_f32 v[66:67], v[40:41], v[40:41]
    v_pk_fma_f32 v[66:67], v[42:43], v[42:43], v[66:67]
    v_pk_fma_f32 v[66:67], v[44:45], v[44:45], v[66:67]
    v_pk_fma_f32 v[66:67], v[46:47], v[46:47], v[66:67]
    v_add_f32 v66, v66, v67
    v_cndmask_b32 v66, 0, v66, s[80:81]
    v_cvt_pk_bf16_f32 v64, v64, v64
    v_and_b32 v64, 0xffff0000, v64
    v_add_f32_dpp v66, v66, v66 quad_perm:[1,0,3,2] row_mask:0xf bank_mask:0xf
    v_mov_b32 v65, v64
    v_pk_add_f32 v[40:41], v[24:25], v[64:65]
    v_add_f32_dpp v66, v66, v66 quad_perm:[2,3,0,1] row_mask:0xf bank_mask:0xf
    v_pk_add_f32 v[42:43], v[26:27], v[64:65]
    v_pk_add_f32 v[44:45], v[28:29], v[64:65]
    v_add_f32_dpp v66, v66, v66 row_ror:8 row_mask:0xf bank_mask:0xf
    v_pk_add_f32 v[46:47], v[30:31], v[64:65]
    v_cvt_pk_bf16_f32 v56, v40, v41
    v_add_f32_dpp v66, v66, v66 row_ror:4 row_mask:0xf bank_mask:0xf
    v_mov_b32 v67, v66
    v_cvt_pk_bf16_f32 v57, v42, v43
    v_cvt_pk_bf16_f32 v58, v44, v45
    v_permlane16_swap_b32 v66, v67
    v_add_f32 v66, v66, v67
    v_mov_b32 v67, v66
    v_cvt_pk_bf16_f32 v59, v46, v47
    v_lshlrev_b32 v40, 16, v56
    v_permlane32_swap_b32 v66, v67
    v_add_f32 v66, v66, v67
    v_mul_f32 v66, 0x3b124925, v66
    v_cvt_pk_bf16_f32 v66, v66, v66
    v_and_b32 v66, 0xffff0000, v66
    v_add_f32 v66, 0x3727c5ac, v66
    v_cvt_pk_bf16_f32 v66, v66, v66
    v_and_b32 v66, 0xffff0000, v66
    v_sqrt_f32 v66, v66
    v_and_b32 v41, 0xffff0000, v56
    v_lshlrev_b32 v42, 16, v57
    v_cvt_pk_bf16_f32 v66, v66, v66
    v_and_b32 v66, 0xffff0000, v66
    v_rcp_f32 v66, v66
    v_and_b32 v43, 0xffff0000, v57
    v_lshlrev_b32 v44, 16, v58
    v_and_b32 v45, 0xffff0000, v58
    v_lshlrev_b32 v46, 16, v59
    v_and_b32 v47, 0xffff0000, v59
    v_pk_mul_f32 v[40:41], v[40:41], v[66:67] op_sel_hi:[1,0]
    v_pk_mul_f32 v[42:43], v[42:43], v[66:67] op_sel_hi:[1,0]
    v_pk_mul_f32 v[44:45], v[44:45], v[66:67] op_sel_hi:[1,0]
    v_pk_mul_f32 v[46:47], v[46:47], v[66:67] op_sel_hi:[1,0]
    v_cvt_pk_bf16_f32 v56, v40, v41
    v_cvt_pk_bf16_f32 v57, v42, v43
    v_cvt_pk_bf16_f32 v58, v44, v45
    v_cvt_pk_bf16_f32 v59, v46, v47
    s_mov_b64 exec, s[80:81]
    ds_write2_b32 v16, v56, v57 offset0:0 offset1:112
    ds_write2_b32 v16, v58, v59 offset0:56 offset1:168
    s_mov_b64 exec, -1
    s_waitcnt lgkmcnt(0)
L_F2:
    s_barrier
    ds_read_b128 v[24:27], v18 offset:0
    ds_read_b128 v[28:31], v18 offset:64
    ds_read_b128 v[32:35], v18 offset:128
    ds_read_b128 v[36:39], v18 offset:192
    ds_read_b128 v[40:43], v18 offset:256
    ds_read_b128 v[44:47], v18 offset:320
    ds_read_b128 v[48:51], v18 offset:384
    v_mov_b32 v79, 0
    v_mov_b32 v78, 0
    v_mov_b32 v77, 0
    v_mov_b32 v76, 0
    v_mov_b32 v75, 0
    v_mov_b32 v74, 0
    v_mov_b32 v73, 0
    v_mov_b32 v72, 0
    v_mov_b32 v71, 0
    v_mov_b32 v70, 0
    v_mov_b32 v69, 0
    v_mov_b32 v68, 0
    v_mov_b32 v67, 0
    v_mov_b32 v66, 0
    v_mov_b32 v65, 0
    v_mov_b32 v64, 0
    v_mov_b32 v63, 0
    v_mov_b32 v62, 0
    v_mov_b32 v61, 0
    v_mov_b32 v60, 0
    s_waitcnt lgkmcnt(6)
    v_smfmac_f32_16x16x64_bf16 v[76:79], v[24:27], v[80:87], v19
    s_waitcnt lgkmcnt(5)
    v_smfmac_f32_16x16x64_bf16 v[76:79], v[28:31], v[88:95], v19
    s_waitcnt lgkmcnt(4)
    v_smfmac_f32_16x16x64_bf16 v[76:79], v[32:35], v[96:103], v19
    s_waitcnt lgkmcnt(3)
    v_smfmac_f32_16x16x64_bf16 v[76:79], v[36:39], v[104:111], v19
    s_waitcnt lgkmcnt(2)
    v_smfmac_f32_16x16x64_bf16 v[76:79], v[40:43], v[112:119], v19
    s_waitcnt lgkmcnt(1)
    v_smfmac_f32_16x16x64_bf16 v[76:79], v[44:47], v[120:127], v19
    s_waitcnt lgkmcnt(0)
    v_smfmac_f32_16x16x64_bf16 v[76:79], v[48:51], v[128:135], v19
    s_nop 7
    v_pk_add_f32 v[52:53], v[76:77], v[78:79]
    v_mov_b32 v54, v52
    s_nop 1
    v_mov_b32_dpp v54, v53 row_ror:8 row_mask:0xf bank_mask:0xc
    v_mov_b32_dpp v53, v52 row_ror:8 row_mask:0xf bank_mask:0x3
    v_cvt_pk_bf16_f32 v55, v54, v53
    v_lshlrev_b32 v54, 16, v55
    v_mul_f32 v52, v54, v54
    v_mul_f32 v53, s77, v54
    v_fma_f32 v52, v52, s76, 1.0
    v_mul_f32 v52, v52, v53
    v_exp_f32 v52, v52
    v_and_b32 v55, 0xffff0000, v55
    v_add_f32 v52, 1.0, v52
    v_rcp_f32 v52, v52
    s_nop 0
    v_mul_f32 v52, v52, v54
    v_cvt_pk_bf16_f32 v52, v52, v52
    v_and_b32 v52, 0xffff0000, v52
    v_mul_f32 v52, v52, v55
    v_cvt_pk_bf16_f32 v52, v52, v52
    ds_write_b16 v20, v52
    s_waitcnt lgkmcnt(0)
    s_barrier
    ds_read_b128 v[40:43], v21
    s_waitcnt lgkmcnt(0)
    v_smfmac_f32_16x16x64_bf16 v[60:63], v[40:43], v[136:143], v19
    v_smfmac_f32_16x16x64_bf16 v[64:67], v[40:43], v[144:151], v19
    v_smfmac_f32_16x16x64_bf16 v[68:71], v[40:43], v[152:159], v19
    v_smfmac_f32_16x16x64_bf16 v[72:75], v[40:43], v[160:167], v19
    s_nop 4
    v_add_f32_dpp v56, v60, v62 quad_perm:[0,1,2,3] row_mask:0x1 bank_mask:0xf
    v_add_f32_dpp v57, v61, v63 quad_perm:[0,1,2,3] row_mask:0x1 bank_mask:0xf
    v_add_f32_dpp v58, v64, v66 quad_perm:[0,1,2,3] row_mask:0x1 bank_mask:0xf
    v_add_f32_dpp v59, v65, v67 quad_perm:[0,1,2,3] row_mask:0x1 bank_mask:0xf
    v_add_f32_dpp v56, v68, v70 quad_perm:[0,1,2,3] row_mask:0x2 bank_mask:0xf
    v_add_f32_dpp v57, v69, v71 quad_perm:[0,1,2,3] row_mask:0x2 bank_mask:0xf
    v_add_f32_dpp v58, v72, v74 quad_perm:[0,1,2,3] row_mask:0x2 bank_mask:0xf
    v_add_f32_dpp v59, v73, v75 quad_perm:[0,1,2,3] row_mask:0x2 bank_mask:0xf
    s_mov_b32 exec_lo, s15
    s_mov_b32 exec_hi, 0
    s_cmp_eq_u32 s79, 1
    s_cbranch_scc0 L_rp_59
    buffer_store_dwordx4 v[56:59], v10, s[60:63], s42 offen
L_re_60:
    s_mov_b64 exec, -1
L_F3:
    s_cmp_lg_u32 s11, 7
    s_cbranch_scc1 L_F4
    s_mov_b32 s82, 0x61a80
L_sp_61:
    buffer_load_dwordx4 v[40:43], v11, s[60:63], s28 offen sc1
    buffer_load_dwordx4 v[44:47], v11, s[60:63], s29 offen sc1
    buffer_load_dwordx4 v[48:51], v11, s[60:63], s30 offen sc1
    buffer_load_dwordx4 v[52:55], v11, s[60:63], s31 offen sc1
    s_waitcnt vmcnt(3)
    v_max3_u32 v72, v40, v41, v42
    v_max_u32 v72, v72, v43
    s_waitcnt vmcnt(2)
    v_max3_u32 v72, v72, v44, v45
    v_max3_u32 v72, v72, v46, v47
    s_waitcnt vmcnt(1)
    v_max3_u32 v72, v72, v48, v49
    v_max3_u32 v72, v72, v50, v51
    s_waitcnt vmcnt(0)
    v_max3_u32 v72, v72, v52, v53
    v_max3_u32 v72, v72, v54, v55
    v_cmp_eq_u32 vcc, -1, v72
    s_cbranch_vccz L_spd_62
    s_mov_b64 exec, vcc
    s_sub_u32 s82, s82, 1
    s_cbranch_scc0 L_sp_61
L_spd_62:
    s_mov_b64 exec, -1
    v_pk_add_f32 v[40:41], v[40:41], v[44:45]
    v_pk_add_f32 v[42:43], v[42:43], v[46:47]
    v_pk_add_f32 v[48:49], v[48:49], v[52:53]
    v_pk_add_f32 v[50:51], v[50:51], v[54:55]
    v_pk_add_f32 v[40:41], v[40:41], v[48:49]
    v_pk_add_f32 v[42:43], v[42:43], v[50:51]
    s_nop 1
    v_permlane32_swap_b32 v40, v42
    v_permlane32_swap_b32 v41, v43
    v_pk_add_f32 v[40:41], v[40:41], v[42:43]
    s_nop 1
    v_permlane16_swap_b32 v40, v41
    v_add_f32 v40, v40, v41
    s_nop 1
    v_add_f32_dpp v40, v40, v40 row_ror:8 row_mask:0xf bank_mask:0xf
    v_cvt_pk_bf16_f32 v40, v40, v40
    v_and_b32 v40, 0xffff0000, v40
    v_add_f32 v15, v15, v40
    v_cvt_pk_bf16_f32 v15, v15, v15
    v_and_b32 v15, 0xffff0000, v15
    s_mov_b32 exec_lo, 0xff00ff
    s_mov_b32 exec_hi, 0xff00ff
    buffer_store_short_d16_hi v15, v14, s[68:71], s43 offen
    s_mov_b64 exec, -1
    s_branch L_fin0
L_F4:
    s_branch L_fin0
    s_cmp_lg_u32 s2, 0
    s_cbranch_scc1 L_fin0
    s_cmp_lg_u32 s11, 6
    s_cbranch_scc1 L_fin0
    s_mov_b64 exec, 1
    buffer_store_dword v3, v2, s[60:63], 0 offen sc1
    s_mov_b64 exec, -1
L_fin0:
L_fin:
L_end:
    s_endpgm
L_rp_13:
    buffer_store_dwordx4 v[12:15], v8, s[60:63], s10 offen offset:0 sc1
    s_branch L_re_14
L_rp_15:
    buffer_store_dwordx4 v[16:19], v8, s[60:63], s11 offen offset:0 sc1
    s_branch L_re_16
L_rp_17:
    buffer_store_dwordx4 v[12:15], v8, s[60:63], s10 offen offset:1024 sc1
    s_branch L_re_18
L_rp_19:
    buffer_store_dwordx4 v[16:19], v8, s[60:63], s11 offen offset:1024 sc1
    s_branch L_re_20
L_rp_21:
    buffer_store_dwordx4 v[12:15], v8, s[60:63], s10 offen offset:2048 sc1
    s_branch L_re_22
L_rp_23:
    buffer_store_dwordx4 v[16:19], v8, s[60:63], s11 offen offset:2048 sc1
    s_branch L_re_24
L_rp_25:
    buffer_store_dwordx4 v[12:15], v8, s[60:63], s10 offen offset:3072 sc1
    s_branch L_re_26
L_rp_27:
    buffer_store_dwordx4 v[16:19], v8, s[60:63], s11 offen offset:3072 sc1
    s_branch L_re_28
L_rp_29:
    buffer_store_dwordx4 v[12:15], v8, s[60:63], s9 offen sc1
    s_branch L_re_30
L_rp_31:
    buffer_store_dwordx4 v[12:15], v8, s[60:63], s9 offen offset:1792 sc1
    s_branch L_re_32
L_rp_45:
    buffer_store_dwordx4 v[164:167], v2, s[60:63], s42 offen sc1
    s_branch L_re_46
L_rp_55:
    buffer_store_dword v15, v13, s[60:63], s40 offen sc1
    s_branch L_re_56
L_rp_59:
    buffer_store_dwordx4 v[56:59], v10, s[60:63], s42 offen sc1
    s_branch L_re_60
.section .rodata,"a"
.p2align 6
.amdhsa_kernel sequential_preLN__gqa_block_cached__geglu_ffn__decode_kernel
  .amdhsa_next_free_vgpr 168
  .amdhsa_next_free_sgpr 102
  .amdhsa_accum_offset 168
  .amdhsa_group_segment_fixed_size 0
  .amdhsa_kernarg_size 96
  .amdhsa_user_sgpr_count 2
  .amdhsa_user_sgpr_kernarg_segment_ptr 1
  .amdhsa_system_sgpr_workgroup_id_x 1
.end_amdhsa_kernel
```
